```python
import torch

def _softmax(x, axis=-1):
    return torch.softmax(x, dim=axis)
def _gelu(x):
    return torch.nn.functional.gelu(x, approximate="tanh")
def _silu(x):
    return torch.nn.functional.silu(x)
def _sigmoid(x):
    return torch.sigmoid(x)
def _layernorm(x, axis=-1, eps=1e-5):
    m = x.mean(dim=axis, keepdim=True)
    v = x.var(dim=axis, keepdim=True, unbiased=False)
    return (x - m) / torch.sqrt(v + eps)
def _scatter_add(tgt, idx, src, axis=0):
    return tgt.clone().index_add_(axis, idx, src)
def _segment_sum(src, seg, n):
    out = torch.zeros((n,) + src.shape[1:], dtype=src.dtype)
    return out.index_add_(0, seg, src)
def _pad(x, pw):
    flat = tuple(v for pair in reversed(pw) for v in pair)
    return torch.nn.functional.pad(x, flat)

kernel_name = 'sequential_preLN__spectral_gfnet__dense_activation_squared_relu__prompt'

def setup_inputs():

    _w = (lambda a: (lambda t: t.to(torch.bfloat16) if t.is_floating_point() else t)(torch.as_tensor(a)))
    def _A_setup():
        B, S, D = 1, 2048, 512
        Df = D // 2 + 1
        return {
            "x": _w((lambda *s: torch.randn(*s, dtype=torch.bfloat16) * 0.05)(B, S, D)),
            "w_r": _w((lambda *s: torch.randn(*s, dtype=torch.bfloat16) * 0.4)(S, Df) * 0.02),
            "w_i": _w((lambda *s: torch.randn(*s, dtype=torch.bfloat16) * 0.4)(S, Df) * 0.02),
        }
    _A_in = _A_setup()

    def _B_setup():
        B, S, D, F = 1, 2048, 512, 1376
        return {
            "x": _w((lambda *s: torch.randn(*s, dtype=torch.bfloat16) * 0.05)(B, S, D)),
            "w1": _w((lambda *s: torch.randn(*s, dtype=torch.bfloat16) * 0.05)(D, F)),
            "b1": _w((lambda *s: torch.randn(*s, dtype=torch.bfloat16) * 0.2)(F)),
            "w2": _w((lambda *s: torch.randn(*s, dtype=torch.bfloat16) * 0.05)(F, D)),
            "b2": _w((lambda *s: torch.randn(*s, dtype=torch.bfloat16) * 0.8)(D)),
        }
    _B_in = _B_setup()

    return {
        "A_x": _A_in["x"],
        "A_w_r": _A_in["w_r"],
        "A_w_i": _A_in["w_i"],
        "B_x": _B_in["x"],
        "B_w1": _B_in["w1"],
        "B_b1": _B_in["b1"],
        "B_w2": _B_in["w2"],
        "B_b2": _B_in["b2"],
    }

def reference(A_x, A_w_r, A_w_i, B_x, B_w1, B_b1, B_w2, B_b2):
    def _A_ref(x, w_r, w_i):
        B, S, D = x.shape
        X = (lambda x, axes=(-2,-1): torch.fft.rfft2(x.float(), dim=axes))(x, axes=(-2, -1))
        W = w_r + 1j * w_i
        X = X * W
        y = (lambda x, s, axes=(-2,-1): torch.fft.irfft2(x, s=s, dim=axes).to(torch.bfloat16))(X, (S, D), axes=(-2, -1))
        return y

    def _B_ref(x, w1, b1, w2, b2):
        h = torch.einsum("bsd,df->bsf", x, w1) + b1
        zero = torch.zeros_like(h)
        r = torch.where(h > zero, h, zero)
        h = r * r
        out = torch.einsum("bsf,fd->bsd", h, w2) + b2
        return out

    x = A_x
    h = x + _A_ref(_layernorm(x, axis=-1), A_w_r, A_w_i)
    h2 = h + _B_ref(_layernorm(h, axis=-1), B_w1, B_b1, B_w2, B_b2)
    return h2
```

```asm
; @launch grid=(256,1,1) block=(256,1,1) lds=163840
.amdgcn_target "amdgcn-amd-amdhsa--gfx950"
.text
.globl sequential_preLN__spectral_gfnet__dense_activation_squared_relu__prompt_kernel
.p2align 8
.type sequential_preLN__spectral_gfnet__dense_activation_squared_relu__prompt_kernel,@function
sequential_preLN__spectral_gfnet__dense_activation_squared_relu__prompt_kernel:
  s_cmp_ge_u32 s2, 256
  s_cbranch_scc1 L_end
  s_load_dwordx2 s[20:21], s[0:1], 80
  s_load_dwordx4 s[4:7], s[0:1], 0
  s_load_dwordx2 s[8:9], s[0:1], 16
  s_load_dwordx8 s[12:19], s[0:1], 32
  s_load_dwordx2 s[10:11], s[0:1], 64
  s_getpc_b64 s[62:63]
  s_lshr_b32 s26, s2, 3
  s_mul_i32 s64, s26, 1024
  v_subrev_u32 v6, 48, v0
  v_lshlrev_b32 v5, 7, v0
  v_min_u32 v4, 7, v6
  v_lshlrev_b32 v4, 7, v4
  v_add_u32 v4, s64, v4
  v_cmp_gt_i32 vcc, 0, v6
  v_min_u32 v4, 30336, v4
  s_nop 0
  v_cndmask_b32 v4, v4, v5, vcc
  v_cmp_gt_u32 vcc, 64, v0
  s_nop 0
  s_and_saveexec_b64 s[66:67], vcc
  s_cbranch_execz L_nopf
  global_load_dword v152, v4, s[62:63]
L_nopf:
  s_mov_b64 exec, s[66:67]
  v_lshrrev_b32 v2, 6, v0
  v_mov_b32 v1, v0
  v_and_b32 v0, 63, v0
  v_readfirstlane_b32 s3, v2
  s_getreg_b32 s71, hwreg(HW_REG_XCC_ID)
  s_and_b32 s25, s2, 7
  s_bfe_u32 s24, s2, 0x30003
  s_lshr_b32 s26, s2, 3
  s_lshr_b32 s27, s2, 6
  s_lshl_b32 s23, s25, 2
  s_add_u32 s23, s23, s27
  s_lshl_b32 s22, s23, 3
  s_add_u32 s22, s22, s24
  s_and_b32 s56, s23, 3
  s_lshl_b32 s56, s56, 9
  s_lshl_b32 s57, s24, 4
  s_add_u32 s56, s56, s57
  s_lshr_b32 s57, s23, 3
  s_lshl_b32 s57, s57, 1
  s_add_u32 s56, s56, s57
  s_bfe_u32 s57, s23, 0x10002
  s_add_u32 s73, s56, s57
  s_and_b32 s57, s3, 1
  s_lshl_b32 s57, s57, 8
  s_add_u32 s56, s73, s57
  s_lshr_b32 s57, s3, 1
  s_lshl_b32 s57, s57, 3
  s_add_u32 s56, s56, s57
  s_lshl_b32 s56, s56, 10
  s_add_u32 s57, s56, 131072
  s_mul_i32 s58, s3, 2080
  v_lshlrev_b32 v12, 4, v0
  v_and_b32 v8, 15, v0
  v_lshrrev_b32 v9, 4, v0
  v_and_b32 v10, 7, v0
  v_bfe_u32 v11, v0, 3, 1
  s_lshl_b32 s59, s26, 3
  s_and_b32 s60, s59, 15
  s_lshr_b32 s61, s59, 6
  s_lshl_b32 s61, s61, 6
  s_add_u32 s60, s60, s61
  s_bfe_u32 s61, s59, 0x20004
  s_lshl_b32 s61, s61, 9
  s_add_u32 s60, s60, s61
  s_lshl_b32 s61, s3, 1
  s_add_u32 s60, s60, s61
  s_mul_i32 s61, s60, 514
  s_lshl_b32 s59, s25, 6
  s_add_u32 s61, s61, s59
  v_bfe_u32 v4, v0, 3, 2
  v_lshlrev_b32 v4, 4, v4
  v_bfe_u32 v2, v0, 2, 1
  v_lshl_add_u32 v4, v2, 8, v4
  v_lshrrev_b32 v2, 5, v0
  v_add_u32 v4, v4, v2
  v_mul_u32_u24 v3, 514, v4
  v_and_b32 v2, 3, v0
  v_lshl_add_u32 v3, v2, 4, v3
  s_lshl_b32 s59, s3, 11
  s_add_u32 s59, s59, 25472
  s_waitcnt lgkmcnt(0)
  s_load_dword s72, s[20:21], 0
  s_mov_b32 s36, s6
  s_mov_b32 s37, s7
  s_mov_b32 s38, 1052672
  s_mov_b32 s39, 0x20000
  s_mov_b32 s40, s8
  s_mov_b32 s41, s9
  s_mov_b32 s42, 1052672
  s_mov_b32 s43, 0x20000
  s_mov_b32 s32, s4
  s_mov_b32 s33, s5
  s_mov_b32 s34, 2097152
  s_mov_b32 s35, 0x20000
  s_mov_b32 m0, s58
  s_nop 0
  buffer_load_dwordx4 v12, s[32:35], s56 offen lds
  s_add_u32 m0, s58, 1040
  s_nop 0
  buffer_load_dwordx4 v12, s[32:35], s57 offen lds
  s_mov_b32 s28, s20
  s_mov_b32 s29, s21
  s_mov_b32 s30, 33554432
  s_mov_b32 s31, 0x20000
  v_mov_b32 v196, -1
  v_mov_b32 v197, -1
  v_mov_b32 v198, -1
  v_mov_b32 v199, -1
  v_lshlrev_b32 v2, 4, v1
  s_lshl_b32 s64, s23, 18
  s_lshl_b32 s68, s24, 13
  s_add_u32 s64, s64, s68
  s_add_u32 s64, s64, 1114112
  s_add_u32 s68, s64, 4096
  buffer_store_dwordx4 v[196:199], v2, s[28:31], s64 offen sc1
  buffer_store_dwordx4 v[196:199], v2, s[28:31], s68 offen sc1
  s_add_u32 s32, s20, 196608
  s_addc_u32 s33, s21, 0
  s_mov_b32 s34, 8192
  s_mov_b32 s35, 0x20000
  s_cmp_eq_u32 s22, 0
  s_cselect_b32 s34, 8192, 0
  s_mov_b32 s44, s12
  s_mov_b32 s45, s13
  s_mov_b32 s46, 1409024
  s_mov_b32 s47, 0x20000
  s_mov_b32 s48, s16
  s_mov_b32 s49, s17
  s_mov_b32 s50, 1409024
  s_mov_b32 s51, 0x20000
  s_mov_b32 s52, s10
  s_mov_b32 s53, s11
  s_mov_b32 s54, 2097152
  s_mov_b32 s55, 0x20000
  s_lshl_b32 s63, s25, 12
  s_add_u32 s63, s63, 163840
  s_mov_b32 s11, s59
  v_cvt_f32_u32 v24, v8
  v_lshlrev_b32 v25, 2, v9
  v_cvt_f32_u32 v25, v25
  v_mul_f32 v26, 0x3d000000, v24
  v_cmp_eq_u32 vcc, 0, v8
  v_mov_b32 v27, 0.5
  v_mov_b32 v28, 0x3e800000
  v_mov_b32 v87, 0x3d800000
  v_cndmask_b32 v27, v26, v27, vcc
  v_cndmask_b32 v28, v28, 0, vcc
  v_cndmask_b32 v87, 0, v87, vcc
  v_add_f32 v29, 0x00000000, v25
  v_mul_f32 v88, v29, v26
  v_fma_f32 v90, v29, v27, v28
  v_cos_f32 v88, v88
  v_cos_f32 v90, v90
  v_add_f32 v29, 0x3f800000, v25
  v_mul_f32 v89, v29, v26
  v_fma_f32 v91, v29, v27, v28
  v_cos_f32 v89, v89
  v_cos_f32 v91, v91
  v_cvt_pk_bf16_f32 v16, v88, v89
  v_cvt_pk_bf16_f32 v20, v90, v91
  v_add_f32 v29, 0x40000000, v25
  v_mul_f32 v88, v29, v26
  v_fma_f32 v90, v29, v27, v28
  v_cos_f32 v88, v88
  v_cos_f32 v90, v90
  v_add_f32 v29, 0x40400000, v25
  v_mul_f32 v89, v29, v26
  v_fma_f32 v91, v29, v27, v28
  v_cos_f32 v89, v89
  v_cos_f32 v91, v91
  v_cvt_pk_bf16_f32 v17, v88, v89
  v_cvt_pk_bf16_f32 v21, v90, v91
  v_add_f32 v29, 0x41800000, v25
  v_mul_f32 v88, v29, v26
  v_fma_f32 v90, v29, v27, v28
  v_cos_f32 v88, v88
  v_cos_f32 v90, v90
  v_add_f32 v29, 0x41880000, v25
  v_mul_f32 v89, v29, v26
  v_fma_f32 v91, v29, v27, v28
  v_cos_f32 v89, v89
  v_cos_f32 v91, v91
  v_cvt_pk_bf16_f32 v18, v88, v89
  v_cvt_pk_bf16_f32 v22, v90, v91
  v_add_f32 v29, 0x41900000, v25
  v_mul_f32 v88, v29, v26
  v_fma_f32 v90, v29, v27, v28
  v_cos_f32 v88, v88
  v_cos_f32 v90, v90
  v_add_f32 v29, 0x41980000, v25
  v_mul_f32 v89, v29, v26
  v_fma_f32 v91, v29, v27, v28
  v_cos_f32 v89, v89
  v_cos_f32 v91, v91
  v_cvt_pk_bf16_f32 v19, v88, v89
  v_cvt_pk_bf16_f32 v23, v90, v91
  s_lshl_b32 s66, s3, 2
  v_cvt_f32_u32 v26, s66
  v_fmac_f32 v26, 0x42000000, v24
  v_mul_f32 v26, 0x3b000000, v26
  v_cmp_lt_u32 vcc, 7, v8
  v_mov_b32 v27, 0x80008000
  s_nop 0
  v_cndmask_b32 v27, 0, v27, vcc
  v_add_f32 v28, 0x00000000, v26
  v_mul_f32 v88, v25, v28
  v_add_f32 v90, v88, v28
  v_add_f32 v92, v90, v28
  v_add_f32 v94, v92, v28
  v_sin_f32 v89, v88
  v_cos_f32 v88, v88
  v_sin_f32 v91, v90
  v_cos_f32 v90, v90
  v_sin_f32 v93, v92
  v_cos_f32 v92, v92
  v_sin_f32 v95, v94
  v_cos_f32 v94, v94
  v_cvt_pk_bf16_f32 v32, v88, v89
  v_cvt_pk_bf16_f32 v36, -v89, v88
  v_xor_b32 v36, v27, v36
  v_cvt_pk_bf16_f32 v33, v90, v91
  v_cvt_pk_bf16_f32 v37, -v91, v90
  v_xor_b32 v37, v27, v37
  v_cvt_pk_bf16_f32 v34, v92, v93
  v_cvt_pk_bf16_f32 v38, -v93, v92
  v_xor_b32 v38, v27, v38
  v_cvt_pk_bf16_f32 v35, v94, v95
  v_cvt_pk_bf16_f32 v39, -v95, v94
  v_xor_b32 v39, v27, v39
  v_add_f32 v28, 0x3b000000, v26
  v_mul_f32 v88, v25, v28
  v_add_f32 v90, v88, v28
  v_add_f32 v92, v90, v28
  v_add_f32 v94, v92, v28
  v_sin_f32 v89, v88
  v_cos_f32 v88, v88
  v_sin_f32 v91, v90
  v_cos_f32 v90, v90
  v_sin_f32 v93, v92
  v_cos_f32 v92, v92
  v_sin_f32 v95, v94
  v_cos_f32 v94, v94
  v_cvt_pk_bf16_f32 v40, v88, v89
  v_cvt_pk_bf16_f32 v44, -v89, v88
  v_xor_b32 v44, v27, v44
  v_cvt_pk_bf16_f32 v41, v90, v91
  v_cvt_pk_bf16_f32 v45, -v91, v90
  v_xor_b32 v45, v27, v45
  v_cvt_pk_bf16_f32 v42, v92, v93
  v_cvt_pk_bf16_f32 v46, -v93, v92
  v_xor_b32 v46, v27, v46
  v_cvt_pk_bf16_f32 v43, v94, v95
  v_cvt_pk_bf16_f32 v47, -v95, v94
  v_xor_b32 v47, v27, v47
  v_add_f32 v28, 0x3b800000, v26
  v_mul_f32 v88, v25, v28
  v_add_f32 v90, v88, v28
  v_add_f32 v92, v90, v28
  v_add_f32 v94, v92, v28
  v_sin_f32 v89, v88
  v_cos_f32 v88, v88
  v_sin_f32 v91, v90
  v_cos_f32 v90, v90
  v_sin_f32 v93, v92
  v_cos_f32 v92, v92
  v_sin_f32 v95, v94
  v_cos_f32 v94, v94
  v_cvt_pk_bf16_f32 v48, v88, v89
  v_cvt_pk_bf16_f32 v52, -v89, v88
  v_xor_b32 v52, v27, v52
  v_cvt_pk_bf16_f32 v49, v90, v91
  v_cvt_pk_bf16_f32 v53, -v91, v90
  v_xor_b32 v53, v27, v53
  v_cvt_pk_bf16_f32 v50, v92, v93
  v_cvt_pk_bf16_f32 v54, -v93, v92
  v_xor_b32 v54, v27, v54
  v_cvt_pk_bf16_f32 v51, v94, v95
  v_cvt_pk_bf16_f32 v55, -v95, v94
  v_xor_b32 v55, v27, v55
  v_add_f32 v28, 0x3bc00000, v26
  v_mul_f32 v88, v25, v28
  v_add_f32 v90, v88, v28
  v_add_f32 v92, v90, v28
  v_add_f32 v94, v92, v28
  v_sin_f32 v89, v88
  v_cos_f32 v88, v88
  v_sin_f32 v91, v90
  v_cos_f32 v90, v90
  v_sin_f32 v93, v92
  v_cos_f32 v92, v92
  v_sin_f32 v95, v94
  v_cos_f32 v94, v94
  v_cvt_pk_bf16_f32 v56, v88, v89
  v_cvt_pk_bf16_f32 v60, -v89, v88
  v_xor_b32 v60, v27, v60
  v_cvt_pk_bf16_f32 v57, v90, v91
  v_cvt_pk_bf16_f32 v61, -v91, v90
  v_xor_b32 v61, v27, v61
  v_cvt_pk_bf16_f32 v58, v92, v93
  v_cvt_pk_bf16_f32 v62, -v93, v92
  v_xor_b32 v62, v27, v62
  v_cvt_pk_bf16_f32 v59, v94, v95
  v_cvt_pk_bf16_f32 v63, -v95, v94
  v_xor_b32 v63, v27, v63
  v_mov_b32 v64, 0
  v_mov_b32 v65, 0
  v_mov_b32 v66, 0
  v_mov_b32 v67, 0
  s_mov_b32 m0, s11
  s_nop 0
  buffer_load_dwordx4 v3, s[36:39], s61 offen lds
  s_add_u32 m0, s11, 1024
  s_nop 0
  buffer_load_dwordx4 v3, s[40:43], s61 offen lds
  s_lshl_b32 s65, s23, 12
  s_add_u32 s65, s65, 4096
  s_lshl_b32 s64, s24, 2
  s_add_u32 s64, s64, s3
  s_mul_i32 s64, s64, 1408
  s_lshl_b32 s68, s23, 18
  s_add_u32 s64, s64, s68
  s_add_u32 s64, s64, 1241600
  s_add_u32 s68, s63, -1024
  v_mov_b32 v5, s64
  v_mov_b32 v6, s68
  v_cmp_gt_u32 vcc, 28, v0
  s_nop 1
  v_cndmask_b32 v5, v5, v6, vcc
  v_mov_b32 v6, s65
  v_cmp_gt_u32 vcc, 24, v0
  s_nop 1
  v_cndmask_b32 v5, v5, v6, vcc
  v_min_u32 v6, 38, v0
  v_lshl_add_u32 v5, v6, 7, v5
  buffer_load_dword v153, v5, s[28:31], 0 offen
  v_bfe_u32 v4, v0, 1, 2
  v_lshlrev_b32 v4, 4, v4
  v_and_b32 v5, 1, v0
  v_lshl_add_u32 v4, v5, 8, v4
  v_add3_u32 v4, v4, v11, s60
  v_mul_u32_u24 v4, 514, v4
  v_add_u32 v5, s25, v9
  v_lshl_add_u32 v4, v5, 24, v4
  buffer_load_ushort v144, v4, s[36:39], 0 offen offset:512
  buffer_load_ushort v145, v4, s[40:43], 0 offen offset:512
  v_mov_b32 v68, 0
  v_mov_b32 v69, 0
  v_mov_b32 v70, 0
  v_mov_b32 v71, 0
  v_mov_b32 v72, 0
  v_mov_b32 v73, 0
  v_mov_b32 v74, 0
  v_mov_b32 v75, 0
  v_mov_b32 v76, 0
  v_mov_b32 v77, 0
  v_mov_b32 v78, 0
  v_mov_b32 v79, 0
  v_lshlrev_b32 v80, 3, v0
  v_add_u32 v80, s58, v80
  v_mul_u32_u24 v81, 528, v8
  v_lshl_add_u32 v81, v9, 7, v81
  s_lshl_b32 s66, s3, 5
  s_add_u32 s66, s66, 8320
  v_add_u32 v81, s66, v81
  v_lshlrev_b32 v82, 4, v10
  v_lshl_add_u32 v82, v9, 7, v82
  s_mul_i32 s66, s3, 2112
  s_add_u32 s66, s66, 8320
  v_add_u32 v82, s66, v82
  v_and_b32 v83, 1, v9
  v_lshlrev_b32 v84, 2, v83
  s_lshl_b32 s66, s3, 3
  s_add_u32 s66, s66, 16768
  v_add_u32 v84, s66, v84
  v_lshlrev_b32 v83, 2, v10
  v_add_u32 v83, 16768, v83
  v_lshlrev_b32 v204, 2, v9
  v_sub_u32 v205, 15, v204
  v_min_u32 v204, v204, v205
  v_lshrrev_b32 v205, 1, v9
  v_lshl_add_u32 v204, v204, 1, v205
  v_lshlrev_b32 v204, 19, v204
  v_lshl_add_u32 v204, v8, 2, v204
  v_lshlrev_b32 v205, 21, v205
  v_sub_u32 v85, 1048576, v205
  v_add_u32 v205, v204, v85
  v_add_u32 v206, v205, v85
  v_add_u32 v207, v206, v85
  s_lshr_b32 s66, s3, 1
  s_lshl_b32 s66, s66, 18
  s_and_b32 s67, s3, 1
  s_lshl_b32 s67, s67, 15
  s_add_u32 s66, s66, s67
  s_lshl_b32 s67, s22, 7
  s_add_u32 s66, s66, s67
  s_add_u32 s66, s66, 1048576
  s_mov_b32 s67, 0xfff8fff8
  v_bfe_u32 v200, v0, 2, 2
  v_lshlrev_b32 v200, 6, v200
  v_lshrrev_b32 v201, 5, v0
  v_lshl_add_u32 v200, v201, 9, v200
  v_and_b32 v202, 1, v9
  v_lshl_add_u32 v200, v202, 5, v200
  v_and_b32 v202, 3, v0
  v_lshl_add_u32 v200, v202, 3, v200
  v_add_u32 v200, s59, v200
  v_lshlrev_b32 v201, 5, v201
  v_lshl_add_u32 v201, v10, 13, v201
  v_bfe_u32 v202, v0, 3, 2
  v_lshl_add_u32 v201, v202, 18, v201
  s_lshl_b32 s59, s25, 20
  s_lshl_b32 s62, s26, 8
  s_add_u32 s59, s59, s62
  s_lshl_b32 s62, s3, 6
  s_add_u32 s59, s59, s62
  s_add_u32 s59, s59, 1179648
  v_mov_b32 v86, 0x3f803f80
  s_mov_b32 s4, 0x00ff00ff
  s_mov_b32 s5, 0x00ff00ff
  s_not_b64 s[6:7], s[4:5]
  s_cmp_lg_u32 s3, 0
  s_cbranch_scc1 sequential_preLN__spectral_gfnet__dense_activation_squared_relu__prompt_kernel_skip1
  v_cmp_lt_u32 vcc, 7, v8
  v_mul_f32 v26, 0x3d800000, v24
  v_sub_f32 v28, 0x3f780000, v26
  v_cndmask_b32 v26, v26, v28, vcc
  v_mov_b32 v27, 0xffff
  v_mov_b32 v28, 0xffff0000
  v_cndmask_b32 v27, v27, v28, vcc
  v_cmp_eq_u32 vcc, 0, v8
  v_add_f32 v29, 0x00000000, v25
  v_mul_f32 v88, v29, v26
  v_sin_f32 v89, v88
  v_cos_f32 v88, v88
  v_mov_b32 v28, -1.0
  v_cndmask_b32 v89, v89, v28, vcc
  v_cvt_pk_bf16_f32 v32, v88, v88
  v_cvt_pk_bf16_f32 v36, -v89, -v89
  v_and_b32 v32, v27, v32
  v_and_b32 v36, v27, v36
  v_add_f32 v29, 0x3f800000, v25
  v_mul_f32 v88, v29, v26
  v_sin_f32 v89, v88
  v_cos_f32 v88, v88
  v_mov_b32 v28, 1.0
  v_cndmask_b32 v89, v89, v28, vcc
  v_cvt_pk_bf16_f32 v33, v88, v88
  v_cvt_pk_bf16_f32 v37, -v89, -v89
  v_and_b32 v33, v27, v33
  v_and_b32 v37, v27, v37
  v_add_f32 v29, 0x40000000, v25
  v_mul_f32 v88, v29, v26
  v_sin_f32 v89, v88
  v_cos_f32 v88, v88
  v_mov_b32 v28, -1.0
  v_cndmask_b32 v89, v89, v28, vcc
  v_cvt_pk_bf16_f32 v34, v88, v88
  v_cvt_pk_bf16_f32 v38, -v89, -v89
  v_and_b32 v34, v27, v34
  v_and_b32 v38, v27, v38
  v_add_f32 v29, 0x40400000, v25
  v_mul_f32 v88, v29, v26
  v_sin_f32 v89, v88
  v_cos_f32 v88, v88
  v_mov_b32 v28, 1.0
  v_cndmask_b32 v89, v89, v28, vcc
  v_cvt_pk_bf16_f32 v35, v88, v88
  v_cvt_pk_bf16_f32 v39, -v89, -v89
  v_and_b32 v35, v27, v35
  v_and_b32 v39, v27, v39
sequential_preLN__spectral_gfnet__dense_activation_squared_relu__prompt_kernel_skip1:
  s_waitcnt lgkmcnt(0)
  s_add_u32 s72, s72, 0x9e3779b9
  s_and_b32 s71, s71, 15
  s_add_u32 s71, s71, s72
  s_add_u32 s71, s71, 1
  s_mov_b32 s70, 0
  s_and_b32 s21, s72, 0x00070007
  s_or_b32 s21, s21, 0x40000
  v_mov_b32 v112, s21
  s_mov_b32 s69, s66
  s_lshl_b32 s66, s2, 2
  s_add_u32 s66, s66, s3
  s_mul_i32 s66, s66, 1408
  v_min_u32 v6, 10, v0
  v_lshlrev_b32 v6, 7, v6
  buffer_load_dword v150, v6, s[44:47], s66 offen
  s_mov_b32 s66, s69
  s_waitcnt vmcnt(8)
  ds_read_b64_tr_b16 v[88:89], v80
  ds_read_b64_tr_b16 v[90:91], v80 offset:512
  ds_read_b64_tr_b16 v[92:93], v80 offset:1040
  ds_read_b64_tr_b16 v[94:95], v80 offset:1552
  v_mov_b32 v24, 0
  v_mov_b32 v25, 0
  v_mov_b32 v26, 0
  v_mov_b32 v27, 0
  s_waitcnt lgkmcnt(2)
  v_mfma_f32_16x16x32_bf16 v[96:99], v[88:91], v[16:19], 0
  v_mfma_f32_16x16x32_bf16 v[100:103], v[88:91], v[20:23], 0
  v_dot2c_f32_bf16 v24, v88, v86
  v_dot2c_f32_bf16 v25, v88, v88
  v_dot2c_f32_bf16 v24, v89, v86
  v_dot2c_f32_bf16 v25, v89, v89
  v_dot2c_f32_bf16 v24, v90, v86
  v_dot2c_f32_bf16 v25, v90, v90
  v_dot2c_f32_bf16 v24, v91, v86
  v_dot2c_f32_bf16 v25, v91, v91
  s_waitcnt lgkmcnt(0)
  v_mfma_f32_16x16x32_bf16 v[104:107], v[92:95], v[16:19], 0
  v_mfma_f32_16x16x32_bf16 v[108:111], v[92:95], v[20:23], 0
  v_dot2c_f32_bf16 v26, v92, v86
  v_dot2c_f32_bf16 v27, v92, v92
  v_dot2c_f32_bf16 v26, v93, v86
  v_dot2c_f32_bf16 v27, v93, v93
  v_dot2c_f32_bf16 v26, v94, v86
  v_dot2c_f32_bf16 v27, v94, v94
  v_dot2c_f32_bf16 v26, v95, v86
  v_dot2c_f32_bf16 v27, v95, v95
  v_permlane32_swap_b32 v24, v25
  v_add_f32 v24, v24, v25
  s_nop 0
  v_permlane32_swap_b32 v26, v27
  v_add_f32 v26, v26, v27
  s_nop 1
  v_permlane16_swap_b32 v24, v26
  v_add_f32 v24, v24, v26
  s_nop 1
  v_add_f32_dpp v24, v24, v24 row_ror:8 row_mask:0xf bank_mask:0xf
  s_nop 1
  v_add_f32_dpp v24, v24, v24 row_ror:4 row_mask:0xf bank_mask:0xf
  s_nop 1
  v_add_f32_dpp v24, v24, v24 row_ror:2 row_mask:0xf bank_mask:0xf
  s_nop 1
  v_add_f32_dpp v24, v24, v24 row_ror:1 row_mask:0xf bank_mask:0xf
  s_nop 0
  v_readlane_b32 s56, v24, 0
  v_readlane_b32 s57, v24, 16
  v_mov_b32 v25, v24
  v_fma_f32 v96, -v87, s56, v96
  v_fma_f32 v97, -v87, s56, v97
  v_fma_f32 v98, -v87, s56, v98
  v_fma_f32 v99, -v87, s56, v99
  v_permlane32_swap_b32 v24, v25
  v_cvt_pk_bf16_f32 v88, v96, v100
  v_cvt_pk_bf16_f32 v89, v97, v101
  v_cvt_pk_bf16_f32 v90, v98, v102
  v_cvt_pk_bf16_f32 v91, v99, v103
  ds_write_b128 v81, v[88:91]
  v_fma_f32 v104, -v87, s57, v104
  v_fma_f32 v105, -v87, s57, v105
  v_fma_f32 v106, -v87, s57, v106
  v_fma_f32 v107, -v87, s57, v107
  v_mul_f32 v24, 0x3b000000, v24
  v_mul_f32 v25, 0x3b000000, v25
  v_cvt_pk_bf16_f32 v92, v104, v108
  v_cvt_pk_bf16_f32 v93, v105, v109
  v_cvt_pk_bf16_f32 v94, v106, v110
  v_cvt_pk_bf16_f32 v95, v107, v111
  ds_write_b128 v81, v[92:95] offset:16
  v_fma_f32 v25, -v24, v24, v25
  v_max_f32 v25, 0, v25
  v_add_f32 v25, 0x3727c5ac, v25
  v_rsq_f32 v25, v25
  s_nop 0
  ds_write_b32 v84, v25
  s_waitcnt vmcnt(6)
  s_waitcnt lgkmcnt(0)
  s_barrier
  s_mov_b64 exec, s[4:5]
  ds_read_b128 v[64:67], v82
  ds_read_b128 v[72:75], v82 offset:1056
  s_mov_b64 exec, s[6:7]
  ds_read_b128 v[68:71], v82 offset:528
  ds_read_b128 v[76:79], v82 offset:1584
  s_mov_b64 exec, -1
  ds_read_b32 v28, v83
  s_waitcnt lgkmcnt(4)
  v_mfma_f32_16x16x32_bf16 v[96:99], v[32:35], v[64:67], 0
  v_mfma_f32_16x16x32_bf16 v[100:103], v[36:39], v[64:67], 0
  s_waitcnt lgkmcnt(3)
  v_mfma_f32_16x16x32_bf16 v[104:107], v[48:51], v[72:75], 0
  v_mfma_f32_16x16x32_bf16 v[108:111], v[52:55], v[72:75], 0
  s_waitcnt lgkmcnt(2)
  v_mfma_f32_16x16x32_bf16 v[96:99], v[40:43], v[68:71], v[96:99]
  v_mfma_f32_16x16x32_bf16 v[100:103], v[44:47], v[68:71], v[100:103]
  s_waitcnt lgkmcnt(1)
  v_mfma_f32_16x16x32_bf16 v[104:107], v[56:59], v[76:79], v[104:107]
  v_mfma_f32_16x16x32_bf16 v[108:111], v[60:63], v[76:79], v[108:111]
  s_waitcnt lgkmcnt(0)
  s_nop 2
  v_pk_mul_f32 v[96:97], v[96:97], v[28:29] op_sel_hi:[1,0]
  v_pk_mul_f32 v[98:99], v[98:99], v[28:29] op_sel_hi:[1,0]
  v_pk_mul_f32 v[100:101], v[100:101], v[28:29] op_sel_hi:[1,0]
  v_pk_mul_f32 v[102:103], v[102:103], v[28:29] op_sel_hi:[1,0]
  v_cvt_pk_f16_f32 v114, v96, v100
  v_cvt_pk_f16_f32 v115, v97, v101
  v_cvt_pk_f16_f32 v116, v98, v102
  v_cvt_pk_f16_f32 v117, v99, v103
  v_and_or_b32 v114, v114, s67, v112
  buffer_store_dword v114, v204, s[28:31], s66 offen offset:0 sc1
  v_and_or_b32 v115, v115, s67, v112
  buffer_store_dword v115, v205, s[28:31], s66 offen offset:0 sc1
  v_and_or_b32 v116, v116, s67, v112
  buffer_store_dword v116, v206, s[28:31], s66 offen offset:0 sc1
  v_and_or_b32 v117, v117, s67, v112
  buffer_store_dword v117, v207, s[28:31], s66 offen offset:0 sc1
  v_pk_mul_f32 v[104:105], v[104:105], v[28:29] op_sel_hi:[1,0]
  v_pk_mul_f32 v[106:107], v[106:107], v[28:29] op_sel_hi:[1,0]
  v_pk_mul_f32 v[108:109], v[108:109], v[28:29] op_sel_hi:[1,0]
  v_pk_mul_f32 v[110:111], v[110:111], v[28:29] op_sel_hi:[1,0]
  v_cvt_pk_f16_f32 v118, v104, v108
  v_cvt_pk_f16_f32 v119, v105, v109
  v_cvt_pk_f16_f32 v120, v106, v110
  v_cvt_pk_f16_f32 v121, v107, v111
  v_and_or_b32 v118, v118, s67, v112
  buffer_store_dword v118, v204, s[28:31], s66 offen offset:64 sc1
  v_and_or_b32 v119, v119, s67, v112
  buffer_store_dword v119, v205, s[28:31], s66 offen offset:64 sc1
  v_and_or_b32 v120, v120, s67, v112
  buffer_store_dword v120, v206, s[28:31], s66 offen offset:64 sc1
  v_and_or_b32 v121, v121, s67, v112
  buffer_store_dword v121, v207, s[28:31], s66 offen offset:64 sc1
  v_cmp_lt_u32 vcc, 25, v0
  v_mov_b32 v6, 2336
  s_nop 0
  v_cndmask_b32 v6, 0, v6, vcc
  v_add_u32 v7, v6, v12
  s_mov_b32 s8, 0xfcffffff
  s_mov_b32 s9, 0x0003ffff
  s_lshl_b32 s68, s3, 1
  s_add_u32 s68, s68, 0
  s_mul_i32 s68, s68, 2752
  s_mul_i32 s69, s24, 384
  s_add_u32 s68, s68, s69
  s_mul_i32 s69, s3, 27008
  s_add_u32 s69, s69, 41856
  s_waitcnt vmcnt(12)
  ds_read_b64_tr_b16 v[192:193], v200
  ds_read_b64_tr_b16 v[194:195], v200 offset:256
  ds_read_b64_tr_b16 v[196:197], v200 offset:1024
  ds_read_b64_tr_b16 v[198:199], v200 offset:1280
  s_waitcnt lgkmcnt(0)
  buffer_store_dwordx4 v[192:195], v201, s[28:31], s59 offen
  buffer_store_dwordx4 v[196:199], v201, s[28:31], s59 offen offset:16
  v_add_u32 v5, s25, v9
  v_lshlrev_b32 v5, 27, v5
  v_lshl_add_u32 v5, v11, 5, v5
  v_lshl_add_u32 v5, v10, 1, v5
  s_lshl_b32 s64, s26, 8
  s_lshl_b32 s20, s3, 6
  s_add_u32 s64, s64, s20
  s_add_u32 s64, s64, 196608
  s_waitcnt vmcnt(12)
  buffer_store_short v144, v5, s[28:31], s64 offen
  s_waitcnt vmcnt(12)
  buffer_store_short v145, v5, s[28:31], s64 offen offset:16
  s_lshl_b32 s66, s2, 2
  s_add_u32 s66, s66, s3
  s_mul_i32 s66, s66, 1408
  v_min_u32 v6, 10, v0
  v_lshlrev_b32 v6, 7, v6
  buffer_load_dword v154, v6, s[48:51], s66 offen
  v_cvt_f32_u32 v156, v8
  v_lshlrev_b32 v157, 2, v9
  v_cvt_f32_u32 v157, v157
  s_lshl_b32 s56, s3, 1
  v_cvt_f32_u32 v158, s56
  v_mul_f32 v159, 0x3a000000, v156
  v_add_f32 v160, 0x00000000, v158
  v_fmac_f32 v160, 0x43000000, v157
  v_mul_f32 v160, v160, v159
  s_add_u32 m0, s69, 0
  s_mov_b64 exec, s[8:9]
  buffer_load_dwordx4 v7, s[44:47], s68 offen lds
  s_mov_b64 exec, -1
  s_add_u32 s68, s68, 44032
  v_mul_f32 v159, 0x43000000, v159
  v_add_f32 v162, v160, v159
  v_add_f32 v164, v162, v159
  v_add_f32 v166, v164, v159
  v_sin_f32 v161, v160
  v_cos_f32 v160, v160
  v_sin_f32 v163, v162
  v_cos_f32 v162, v162
  v_sin_f32 v165, v164
  s_add_u32 m0, s69, 832
  s_mov_b64 exec, s[8:9]
  buffer_load_dwordx4 v7, s[44:47], s68 offen lds
  s_mov_b64 exec, -1
  s_add_u32 s68, s68, 44032
  v_cos_f32 v164, v164
  v_sin_f32 v167, v166
  v_cos_f32 v166, v166
  v_cvt_pk_f16_f32 v56, v160, v161
  v_cvt_pk_f16_f32 v60, -v161, v160
  v_cvt_pk_f16_f32 v57, v162, v163
  v_cvt_pk_f16_f32 v61, -v163, v162
  v_cvt_pk_f16_f32 v58, v164, v165
  v_cvt_pk_f16_f32 v62, -v165, v164
  s_add_u32 m0, s69, 1664
  s_mov_b64 exec, s[8:9]
  buffer_load_dwordx4 v7, s[44:47], s68 offen lds
  s_mov_b64 exec, -1
  s_add_u32 s68, s68, 44032
  v_cvt_pk_f16_f32 v59, v166, v167
  v_cvt_pk_f16_f32 v63, -v167, v166
  v_mul_f32 v159, 0x3a000000, v156
  v_add_f32 v160, 0x3f800000, v158
  v_fmac_f32 v160, 0x43000000, v157
  v_mul_f32 v160, v160, v159
  v_mul_f32 v159, 0x43000000, v159
  v_add_f32 v162, v160, v159
  v_add_f32 v164, v162, v159
  s_add_u32 m0, s69, 2496
  s_mov_b64 exec, s[8:9]
  buffer_load_dwordx4 v7, s[44:47], s68 offen lds
  s_mov_b64 exec, -1
  s_add_u32 s68, s68, 44032
  v_add_f32 v166, v164, v159
  v_sin_f32 v161, v160
  v_cos_f32 v160, v160
  v_sin_f32 v163, v162
  v_cos_f32 v162, v162
  v_sin_f32 v165, v164
  v_cos_f32 v164, v164
  v_sin_f32 v167, v166
  v_cos_f32 v166, v166
  s_add_u32 m0, s69, 3328
  s_mov_b64 exec, s[8:9]
  buffer_load_dwordx4 v7, s[44:47], s68 offen lds
  s_mov_b64 exec, -1
  s_add_u32 s68, s68, 44032
  v_cvt_pk_f16_f32 v64, v160, v161
  v_cvt_pk_f16_f32 v68, -v161, v160
  v_cvt_pk_f16_f32 v65, v162, v163
  v_cvt_pk_f16_f32 v69, -v163, v162
  v_cvt_pk_f16_f32 v66, v164, v165
  v_cvt_pk_f16_f32 v70, -v165, v164
  v_cvt_pk_f16_f32 v67, v166, v167
  v_cvt_pk_f16_f32 v71, -v167, v166
  v_mul_f32 v159, 0x3b800000, v156
  s_add_u32 m0, s69, 4160
  s_mov_b64 exec, s[8:9]
  buffer_load_dwordx4 v7, s[44:47], s68 offen lds
  s_mov_b64 exec, -1
  s_add_u32 s68, s68, 44032
  v_mul_f32 v120, v157, v159
  v_add_f32 v121, v120, v159
  v_add_f32 v122, v121, v159
  v_add_f32 v123, v122, v159
  v_sin_f32 v124, v120
  v_cos_f32 v120, v120
  v_sin_f32 v125, v121
  v_cos_f32 v121, v121
  v_sin_f32 v126, v122
  s_add_u32 m0, s69, 4992
  s_mov_b64 exec, s[8:9]
  buffer_load_dwordx4 v7, s[44:47], s68 offen lds
  s_mov_b64 exec, -1
  s_add_u32 s68, s68, 44032
  v_cos_f32 v122, v122
  v_sin_f32 v127, v123
  v_cos_f32 v123, v123
  v_mul_f32 v159, 0x3c000000, v156
  v_add_f32 v160, 0x00000000, v158
  v_fmac_f32 v160, 0x41000000, v157
  v_mul_f32 v160, v160, v159
  v_mul_f32 v159, 0x41000000, v159
  v_add_f32 v162, v160, v159
  s_add_u32 m0, s69, 5824
  s_mov_b64 exec, s[8:9]
  buffer_load_dwordx4 v7, s[44:47], s68 offen lds
  s_mov_b64 exec, -1
  s_add_u32 s68, s68, 44032
  v_add_f32 v164, v162, v159
  v_add_f32 v166, v164, v159
  v_sin_f32 v161, v160
  v_cos_f32 v160, v160
  v_sin_f32 v163, v162
  v_cos_f32 v162, v162
  v_sin_f32 v165, v164
  v_cos_f32 v164, v164
  v_sin_f32 v167, v166
  s_add_u32 m0, s69, 6656
  s_mov_b64 exec, s[8:9]
  buffer_load_dwordx4 v7, s[44:47], s68 offen lds
  s_mov_b64 exec, -1
  s_add_u32 s68, s68, 44032
  v_cos_f32 v166, v166
  v_cvt_pk_bf16_f32 v72, v160, v161
  v_cvt_pk_bf16_f32 v76, -v161, v160
  v_cvt_pk_bf16_f32 v73, v162, v163
  v_cvt_pk_bf16_f32 v77, -v163, v162
  v_cvt_pk_bf16_f32 v74, v164, v165
  v_cvt_pk_bf16_f32 v78, -v165, v164
  v_cvt_pk_bf16_f32 v75, v166, v167
  v_cvt_pk_bf16_f32 v79, -v167, v166
  s_add_u32 m0, s69, 7488
  s_mov_b64 exec, s[8:9]
  buffer_load_dwordx4 v7, s[44:47], s68 offen lds
  s_mov_b64 exec, -1
  s_add_u32 s68, s68, 44032
  v_mul_f32 v159, 0x3c000000, v156
  v_add_f32 v160, 0x3f800000, v158
  v_fmac_f32 v160, 0x41000000, v157
  v_mul_f32 v160, v160, v159
  v_mul_f32 v159, 0x41000000, v159
  v_add_f32 v162, v160, v159
  v_add_f32 v164, v162, v159
  v_add_f32 v166, v164, v159
  v_sin_f32 v161, v160
  s_add_u32 m0, s69, 8320
  s_mov_b64 exec, s[8:9]
  buffer_load_dwordx4 v7, s[44:47], s68 offen lds
  s_mov_b64 exec, -1
  s_add_u32 s68, s68, 44032
  v_cos_f32 v160, v160
  v_sin_f32 v163, v162
  v_cos_f32 v162, v162
  v_sin_f32 v165, v164
  v_cos_f32 v164, v164
  v_sin_f32 v167, v166
  v_cos_f32 v166, v166
  v_cvt_pk_bf16_f32 v80, v160, v161
  v_cvt_pk_bf16_f32 v84, -v161, v160
  s_add_u32 m0, s69, 9152
  s_mov_b64 exec, s[8:9]
  buffer_load_dwordx4 v7, s[44:47], s68 offen lds
  s_mov_b64 exec, -1
  s_add_u32 s68, s68, 44032
  v_cvt_pk_bf16_f32 v81, v162, v163
  v_cvt_pk_bf16_f32 v85, -v163, v162
  v_cvt_pk_bf16_f32 v82, v164, v165
  v_cvt_pk_bf16_f32 v86, -v165, v164
  v_cvt_pk_bf16_f32 v83, v166, v167
  v_cvt_pk_bf16_f32 v87, -v167, v166
  v_lshrrev_b32 v159, 1, v8
  v_cvt_f32_u32 v159, v159
  v_mul_f32 v159, 0x3e000000, v159
  v_and_b32 v160, 1, v8
  v_cvt_f32_u32 v160, v160
  v_mul_f32 v160, 0x3e800000, v160
  v_mul_f32 v165, 0.5, v157
  v_fma_f32 v161, v159, v165, v160
  v_fma_f32 v163, -v159, v165, v160
  v_sin_f32 v162, v161
  v_cos_f32 v161, v161
  v_sin_f32 v164, v163
  v_cos_f32 v163, v163
  v_cvt_pk_bf16_f32 v128, v161, v162
  v_mul_f32 v163, 0x36000000, v163
  v_mul_f32 v164, 0x36000000, v164
  v_cvt_pk_bf16_f32 v130, v163, v164
  v_add_f32 v165, 1.0, v165
  v_fma_f32 v161, v159, v165, v160
  v_fma_f32 v163, -v159, v165, v160
  v_sin_f32 v162, v161
  v_cos_f32 v161, v161
  v_sin_f32 v164, v163
  v_cos_f32 v163, v163
  v_cvt_pk_bf16_f32 v129, v161, v162
  v_mul_f32 v163, 0x36000000, v163
  v_mul_f32 v164, 0x36000000, v164
  v_cvt_pk_bf16_f32 v131, v163, v164
  v_add_f32 v159, 0x00000000, v158
  v_fmac_f32 v159, 0x41000000, v156
  v_mul_f32 v159, 0x3c000000, v159
  v_mul_f32 v160, v157, v159
  v_add_f32 v162, v160, v159
  v_add_f32 v164, v162, v159
  v_add_f32 v166, v164, v159
  v_sin_f32 v161, v160
  v_cmp_eq_u32 vcc, 0, v0
  v_mov_b32 v5, 2146435072
  v_mov_b32 v6, s71
  v_cndmask_b32 v5, v5, 0, vcc
  s_lshl_b32 s64, s26, 4
  s_lshl_b32 s66, s3, 2
  s_add_u32 s64, s64, s66
  s_add_u32 s64, s64, s63
  s_waitcnt vmcnt(13)
  buffer_store_dword v6, v5, s[28:31], s64 offen offset:2048
  v_cos_f32 v160, v160
  v_sin_f32 v163, v162
  v_cos_f32 v162, v162
  v_sin_f32 v165, v164
  v_cos_f32 v164, v164
  v_sin_f32 v167, v166
  v_cos_f32 v166, v166
  v_cvt_pk_bf16_f32 v88, v160, -v161
  v_cvt_pk_bf16_f32 v92, v161, v160
  s_add_u32 m0, s69, 9984
  s_mov_b64 exec, s[8:9]
  buffer_load_dwordx4 v7, s[44:47], s68 offen lds
  s_mov_b64 exec, -1
  s_add_u32 s68, s68, 44032
  v_cvt_pk_bf16_f32 v89, v162, -v163
  v_cvt_pk_bf16_f32 v93, v163, v162
  v_cvt_pk_bf16_f32 v90, v164, -v165
  v_cvt_pk_bf16_f32 v94, v165, v164
  v_cvt_pk_bf16_f32 v91, v166, -v167
  v_cvt_pk_bf16_f32 v95, v167, v166
  v_add_f32 v159, 0x3f800000, v158
  v_fmac_f32 v159, 0x41000000, v156
  v_mul_f32 v159, 0x3c000000, v159
  s_add_u32 m0, s69, 10816
  s_mov_b64 exec, s[8:9]
  buffer_load_dwordx4 v7, s[44:47], s68 offen lds
  s_mov_b64 exec, -1
  s_add_u32 s68, s68, 44032
  v_mul_f32 v160, v157, v159
  v_add_f32 v162, v160, v159
  v_add_f32 v164, v162, v159
  v_add_f32 v166, v164, v159
  v_sin_f32 v161, v160
  v_cos_f32 v160, v160
  v_sin_f32 v163, v162
  v_cos_f32 v162, v162
  v_sin_f32 v165, v164
  s_add_u32 m0, s69, 11648
  s_mov_b64 exec, s[8:9]
  buffer_load_dwordx4 v7, s[44:47], s68 offen lds
  s_mov_b64 exec, -1
  s_add_u32 s68, s68, 44032
  v_cos_f32 v164, v164
  v_sin_f32 v167, v166
  v_cos_f32 v166, v166
  v_cvt_pk_bf16_f32 v96, v160, -v161
  v_cvt_pk_bf16_f32 v100, v161, v160
  v_cvt_pk_bf16_f32 v97, v162, -v163
  v_cvt_pk_bf16_f32 v101, v163, v162
  v_cvt_pk_bf16_f32 v98, v164, -v165
  v_cvt_pk_bf16_f32 v102, v165, v164
  s_add_u32 m0, s69, 12480
  s_mov_b64 exec, s[8:9]
  buffer_load_dwordx4 v7, s[44:47], s68 offen lds
  s_mov_b64 exec, -1
  s_add_u32 s68, s68, 44032
  v_cvt_pk_bf16_f32 v99, v166, -v167
  v_cvt_pk_bf16_f32 v103, v167, v166
  v_add_f32 v159, 0x00000000, v158
  v_fmac_f32 v159, 0x43000000, v156
  v_mul_f32 v159, 0x3a000000, v159
  v_mul_f32 v160, v157, v159
  v_add_f32 v162, v160, v159
  v_add_f32 v164, v162, v159
  v_add_f32 v166, v164, v159
  s_add_u32 m0, s69, 13504
  s_mov_b64 exec, s[8:9]
  buffer_load_dwordx4 v7, s[44:47], s68 offen lds
  s_mov_b64 exec, -1
  s_add_u32 s68, s68, 44032
  v_sin_f32 v161, v160
  v_cos_f32 v160, v160
  v_sin_f32 v163, v162
  v_cos_f32 v162, v162
  v_sin_f32 v165, v164
  v_cos_f32 v164, v164
  v_sin_f32 v167, v166
  v_cos_f32 v166, v166
  v_cvt_pk_bf16_f32 v104, v160, -v161
  s_add_u32 m0, s69, 14336
  s_mov_b64 exec, s[8:9]
  buffer_load_dwordx4 v7, s[44:47], s68 offen lds
  s_mov_b64 exec, -1
  s_add_u32 s68, s68, 44032
  v_cvt_pk_bf16_f32 v108, v161, v160
  v_cvt_pk_bf16_f32 v105, v162, -v163
  v_cvt_pk_bf16_f32 v109, v163, v162
  v_cvt_pk_bf16_f32 v106, v164, -v165
  v_cvt_pk_bf16_f32 v110, v165, v164
  v_cvt_pk_bf16_f32 v107, v166, -v167
  v_cvt_pk_bf16_f32 v111, v167, v166
  v_add_f32 v159, 0x3f800000, v158
  v_fmac_f32 v159, 0x43000000, v156
  s_add_u32 m0, s69, 15168
  s_mov_b64 exec, s[8:9]
  buffer_load_dwordx4 v7, s[44:47], s68 offen lds
  s_mov_b64 exec, -1
  s_add_u32 s68, s68, 44032
  v_mul_f32 v159, 0x3a000000, v159
  v_mul_f32 v160, v157, v159
  v_add_f32 v162, v160, v159
  v_add_f32 v164, v162, v159
  v_add_f32 v166, v164, v159
  v_sin_f32 v161, v160
  v_cos_f32 v160, v160
  v_sin_f32 v163, v162
  v_cos_f32 v162, v162
  s_add_u32 m0, s69, 16000
  s_mov_b64 exec, s[8:9]
  buffer_load_dwordx4 v7, s[44:47], s68 offen lds
  s_mov_b64 exec, -1
  s_add_u32 s68, s68, 44032
  v_sin_f32 v165, v164
  v_cos_f32 v164, v164
  v_sin_f32 v167, v166
  v_cos_f32 v166, v166
  s_add_u32 m0, s69, 16832
  s_mov_b64 exec, s[8:9]
  buffer_load_dwordx4 v7, s[44:47], s68 offen lds
  s_mov_b64 exec, -1
  s_add_u32 s68, s68, 44032
  s_add_u32 m0, s69, 17664
  s_mov_b64 exec, s[8:9]
  buffer_load_dwordx4 v7, s[44:47], s68 offen lds
  s_mov_b64 exec, -1
  s_add_u32 s68, s68, 44032
  s_add_u32 m0, s69, 18496
  s_mov_b64 exec, s[8:9]
  buffer_load_dwordx4 v7, s[44:47], s68 offen lds
  s_mov_b64 exec, -1
  s_add_u32 s68, s68, 44032
  s_add_u32 m0, s69, 19328
  s_mov_b64 exec, s[8:9]
  buffer_load_dwordx4 v7, s[44:47], s68 offen lds
  s_mov_b64 exec, -1
  s_add_u32 s68, s68, 44032
  s_add_u32 m0, s69, 20160
  s_mov_b64 exec, s[8:9]
  buffer_load_dwordx4 v7, s[44:47], s68 offen lds
  s_mov_b64 exec, -1
  s_add_u32 s68, s68, 44032
  s_add_u32 m0, s69, 20992
  s_mov_b64 exec, s[8:9]
  buffer_load_dwordx4 v7, s[44:47], s68 offen lds
  s_mov_b64 exec, -1
  s_add_u32 s68, s68, 44032
  s_add_u32 m0, s69, 21824
  s_mov_b64 exec, s[8:9]
  buffer_load_dwordx4 v7, s[44:47], s68 offen lds
  s_mov_b64 exec, -1
  s_add_u32 s68, s68, 44032
  s_add_u32 m0, s69, 22656
  s_mov_b64 exec, s[8:9]
  buffer_load_dwordx4 v7, s[44:47], s68 offen lds
  s_mov_b64 exec, -1
  s_add_u32 s68, s68, 44032
  s_add_u32 m0, s69, 23488
  s_mov_b64 exec, s[8:9]
  buffer_load_dwordx4 v7, s[44:47], s68 offen lds
  s_mov_b64 exec, -1
  s_add_u32 s68, s68, 44032
  s_add_u32 m0, s69, 24320
  s_mov_b64 exec, s[8:9]
  buffer_load_dwordx4 v7, s[44:47], s68 offen lds
  s_mov_b64 exec, -1
  s_add_u32 s68, s68, 44032
  s_add_u32 m0, s69, 25152
  s_mov_b64 exec, s[8:9]
  buffer_load_dwordx4 v7, s[44:47], s68 offen lds
  s_mov_b64 exec, -1
  s_add_u32 s68, s68, 44032
  s_add_u32 m0, s69, 25984
  s_mov_b64 exec, s[8:9]
  buffer_load_dwordx4 v7, s[44:47], s68 offen lds
  s_mov_b64 exec, -1
  s_add_u32 s68, s68, 44032
  v_cvt_pk_bf16_f32 v112, v160, -v161
  v_cvt_pk_bf16_f32 v116, v161, v160
  v_cvt_pk_bf16_f32 v113, v162, -v163
  v_cvt_pk_bf16_f32 v117, v163, v162
  v_cvt_pk_bf16_f32 v114, v164, -v165
  v_cvt_pk_bf16_f32 v118, v165, v164
  v_cvt_pk_bf16_f32 v115, v166, -v167
  v_cvt_pk_bf16_f32 v119, v167, v166
  v_lshlrev_b32 v168, 10, v9
  v_lshl_add_u32 v168, v8, 4, v168
  s_lshl_b32 s56, s3, 8
  v_add_u32 v168, s56, v168
  s_lshl_b32 s56, s3, 10
  v_add_u32 v169, s56, v12
  v_lshlrev_b32 v170, 18, v9
  v_lshl_add_u32 v170, v8, 4, v170
  v_lshrrev_b32 v171, 1, v8
  v_lshlrev_b32 v171, 7, v171
  v_lshl_add_u32 v171, v9, 10, v171
  v_and_b32 v172, 1, v8
  v_lshl_add_u32 v171, v172, 4, v171
  v_lshlrev_b32 v172, 5, v1
  v_lshlrev_b32 v173, 3, v0
  s_lshl_b32 s56, s23, 18
  s_lshr_b32 s57, s24, 2
  s_lshl_b32 s57, s57, 15
  s_add_u32 s56, s56, s57
  s_and_b32 s57, s24, 3
  s_lshl_b32 s57, s57, 5
  s_add_u32 s56, s56, s57
  s_lshl_b32 s57, s3, 13
  s_add_u32 s56, s56, s57
  s_add_u32 s56, s56, 1048576
  s_add_u32 s57, s56, 4096
  s_and_b32 s60, s27, 1
  s_lshl_b32 s60, s60, 3
  s_add_u32 s60, s60, s24
  s_sub_u32 s58, 32, s60
  s_cmp_eq_u32 s60, 0
  s_cselect_b32 s58, 16, s58
  s_cmp_ge_u32 s27, 2
  s_cselect_b32 s58, s58, s60
  s_and_b32 s59, s58, 7
  s_lshl_b32 s59, s59, 13
  s_lshr_b32 s58, s58, 3
  s_lshl_b32 s58, s58, 18
  s_add_u32 s58, s58, s59
  s_lshl_b32 s59, s25, 20
  s_add_u32 s58, s58, s59
  s_add_u32 s58, s58, 1179648
  s_lshl_b32 s60, s60, 4
  s_sub_u32 s61, 15, s25
  s_cmp_ge_u32 s27, 2
  s_cselect_b32 s61, s61, s25
  s_add_u32 s60, s60, s61
  s_lshl_b32 s60, s60, 8
  s_lshl_b32 s61, s3, 21
  s_add_u32 s60, s60, s61
  s_add_u32 s60, s60, 1114112
  s_add_u32 s61, s60, 1048576
  buffer_load_dwordx4 v[16:19], v171, s[28:31], s56 offen sc1
  buffer_load_dwordx4 v[20:23], v171, s[28:31], s57 offen sc1
  buffer_load_dwordx2 v[32:33], v173, s[28:31], s63 offen offset:2048 sc1
  v_bfe_u32 v184, v0, 2, 2
  v_lshl_add_u32 v184, v9, 3, v184
  v_mul_u32_u24 v184, 416, v184
  v_and_b32 v185, 3, v0
  v_lshl_add_u32 v184, v185, 3, v184
  s_lshr_b32 s68, s3, 1
  s_mul_i32 s68, s68, 192
  s_and_b32 s69, s3, 1
  s_lshl_b32 s69, s69, 5
  s_add_u32 s68, s68, 41856
  s_add_u32 s69, s69, s68
  s_add_u32 s69, s69, 64
  v_add_u32 v185, s69, v184
  s_and_b32 s69, s3, 1
  s_lshl_b32 s69, s69, 7
  s_add_u32 s69, s69, s68
  v_add_u32 v184, s69, v184
  v_add_u32 v186, 54016, v184
  v_add_u32 v187, 54016, v185
  s_waitcnt vmcnt(2)
  v_bitop3_b32 v176, v16, v17, s21 bitop3:0x7e
  v_bitop3_b32 v177, v18, v19, s21 bitop3:0x7e
  s_waitcnt vmcnt(1)
  v_bitop3_b32 v178, v20, v21, s21 bitop3:0x7e
  v_bitop3_b32 v179, v22, v23, s21 bitop3:0x7e
  v_or3_b32 v176, v176, v177, v178
  v_or_b32 v176, v176, v179
  v_and_b32 v176, 0x00070007, v176
  v_cmp_ne_u32 vcc, 0, v176
  s_nop 1
  s_cbranch_vccnz pz_retry
pz_ok:
  s_barrier
  v_mfma_f32_16x16x32_f16 v[132:135], v[16:19], v[56:59], 0
  v_mfma_f32_16x16x32_f16 v[136:139], v[16:19], v[60:63], 0
  v_mfma_f32_16x16x32_f16 v[140:143], v[20:23], v[64:67], 0
  v_mfma_f32_16x16x32_f16 v[144:147], v[20:23], v[68:71], 0
  ds_read_b64_tr_b16 a[0:1], v184 offset:0
  ds_read_b64_tr_b16 a[2:3], v184 offset:1664
  ds_read_b64_tr_b16 a[64:65], v184 offset:32
  ds_read_b64_tr_b16 a[66:67], v184 offset:1696
  ds_read_b64_tr_b16 a[128:129], v185 offset:0
  ds_read_b64_tr_b16 a[130:131], v185 offset:1664
  ds_read_b64_tr_b16 a[4:5], v184 offset:13504
  ds_read_b64_tr_b16 a[6:7], v184 offset:15168
  s_waitcnt vmcnt(0)
  v_cmpx_eq_u32 vcc, s71, v32
  v_cmpx_eq_u32 vcc, s71, v33
  s_nop 0
  s_cmp_eq_u64 exec, -1
  s_mov_b64 exec, -1
  s_cbranch_scc0 pwf_retry
pwf_ok:
  buffer_load_dwordx4 v[24:27], v172, s[28:31], s58 offen sc1
  buffer_load_dwordx4 v[28:31], v172, s[28:31], s58 offen offset:16 sc1
  buffer_load_dwordx4 v[176:179], v172, s[32:35], 0 offen sc1
  buffer_load_dwordx4 v[180:183], v172, s[32:35], 0 offen offset:16 sc1
  v_pk_mul_f32 v[156:157], v[132:133], v[120:121]
  ds_read_b64_tr_b16 a[68:69], v184 offset:13536
  ds_read_b64_tr_b16 a[70:71], v184 offset:15200
  v_pk_mul_f32 v[148:149], v[136:137], v[120:121]
  ds_read_b64_tr_b16 a[132:133], v185 offset:13504
  ds_read_b64_tr_b16 a[134:135], v185 offset:15168
  v_pk_fma_f32 v[156:157], v[136:137], v[124:125], v[156:157]
  ds_read_b64_tr_b16 a[8:9], v184 offset:27008
  ds_read_b64_tr_b16 a[10:11], v184 offset:28672
  v_pk_fma_f32 v[148:149], v[132:133], v[124:125], v[148:149] neg_lo:[0,1,0] neg_hi:[0,1,0]
  s_waitcnt lgkmcnt(12)
  ds_read_b64_tr_b16 a[72:73], v184 offset:27040
  ds_read_b64_tr_b16 a[74:75], v184 offset:28704
  v_pk_mul_f32 v[158:159], v[134:135], v[122:123]
  s_waitcnt lgkmcnt(12)
  ds_read_b64_tr_b16 a[136:137], v185 offset:27008
  ds_read_b64_tr_b16 a[138:139], v185 offset:28672
  v_pk_mul_f32 v[150:151], v[138:139], v[122:123]
  s_waitcnt lgkmcnt(12)
  ds_read_b64_tr_b16 a[12:13], v184 offset:40512
  ds_read_b64_tr_b16 a[14:15], v184 offset:42176
  v_pk_fma_f32 v[158:159], v[138:139], v[126:127], v[158:159]
  s_waitcnt lgkmcnt(12)
  ds_read_b64_tr_b16 a[76:77], v184 offset:40544
  ds_read_b64_tr_b16 a[78:79], v184 offset:42208
  v_pk_fma_f32 v[150:151], v[134:135], v[126:127], v[150:151] neg_lo:[0,1,0] neg_hi:[0,1,0]
  s_waitcnt lgkmcnt(12)
  ds_read_b64_tr_b16 a[140:141], v185 offset:40512
  ds_read_b64_tr_b16 a[142:143], v185 offset:42176
  v_cvt_pk_bf16_f32 v16, v156, v148
  s_waitcnt lgkmcnt(12)
  ds_read_b64_tr_b16 a[16:17], v186 offset:0
  ds_read_b64_tr_b16 a[18:19], v186 offset:1664
  v_cvt_pk_bf16_f32 v17, v157, v149
  s_waitcnt lgkmcnt(12)
  ds_read_b64_tr_b16 a[80:81], v186 offset:32
  ds_read_b64_tr_b16 a[82:83], v186 offset:1696
  v_cvt_pk_bf16_f32 v18, v158, v150
  s_waitcnt lgkmcnt(12)
  ds_read_b64_tr_b16 a[144:145], v187 offset:0
  ds_read_b64_tr_b16 a[146:147], v187 offset:1664
  v_cvt_pk_bf16_f32 v19, v159, v151
  s_waitcnt lgkmcnt(12)
  ds_read_b64_tr_b16 a[20:21], v186 offset:13504
  ds_read_b64_tr_b16 a[22:23], v186 offset:15168
  v_pk_mul_f32 v[160:161], v[140:141], v[120:121]
  s_waitcnt lgkmcnt(12)
  ds_read_b64_tr_b16 a[84:85], v186 offset:13536
  ds_read_b64_tr_b16 a[86:87], v186 offset:15200
  v_pk_mul_f32 v[152:153], v[144:145], v[120:121]
  s_waitcnt lgkmcnt(12)
  ds_read_b64_tr_b16 a[148:149], v187 offset:13504
  ds_read_b64_tr_b16 a[150:151], v187 offset:15168
  v_pk_fma_f32 v[160:161], v[144:145], v[124:125], v[160:161]
  s_waitcnt lgkmcnt(12)
  ds_read_b64_tr_b16 a[24:25], v186 offset:27008
  ds_read_b64_tr_b16 a[26:27], v186 offset:28672
  v_pk_fma_f32 v[152:153], v[140:141], v[124:125], v[152:153] neg_lo:[0,1,0] neg_hi:[0,1,0]
  s_waitcnt lgkmcnt(12)
  ds_read_b64_tr_b16 a[88:89], v186 offset:27040
  ds_read_b64_tr_b16 a[90:91], v186 offset:28704
  v_pk_mul_f32 v[162:163], v[142:143], v[122:123]
  s_waitcnt lgkmcnt(12)
  ds_read_b64_tr_b16 a[152:153], v187 offset:27008
  ds_read_b64_tr_b16 a[154:155], v187 offset:28672
  v_pk_mul_f32 v[154:155], v[146:147], v[122:123]
  s_waitcnt lgkmcnt(12)
  ds_read_b64_tr_b16 a[28:29], v186 offset:40512
  ds_read_b64_tr_b16 a[30:31], v186 offset:42176
  v_pk_fma_f32 v[162:163], v[146:147], v[126:127], v[162:163]
  s_waitcnt lgkmcnt(12)
  ds_read_b64_tr_b16 a[92:93], v186 offset:40544
  ds_read_b64_tr_b16 a[94:95], v186 offset:42208
  v_pk_fma_f32 v[154:155], v[142:143], v[126:127], v[154:155] neg_lo:[0,1,0] neg_hi:[0,1,0]
  s_waitcnt lgkmcnt(12)
  ds_read_b64_tr_b16 a[156:157], v187 offset:40512
  ds_read_b64_tr_b16 a[158:159], v187 offset:42176
  v_cvt_pk_bf16_f32 v20, v160, v152
  v_cvt_pk_bf16_f32 v21, v161, v153
  v_cvt_pk_bf16_f32 v22, v162, v154
  v_cvt_pk_bf16_f32 v23, v163, v155
  v_mfma_f32_16x16x32_bf16 v[132:135], v[72:75], v[16:19], 0
  v_mfma_f32_16x16x32_bf16 v[136:139], v[76:79], v[16:19], 0
  v_mfma_f32_16x16x32_bf16 v[140:143], v[80:83], v[20:23], 0
  v_mfma_f32_16x16x32_bf16 v[144:147], v[84:87], v[20:23], 0
  s_nop 5
  v_cvt_pk_bf16_f32 v16, v132, v136
  v_cvt_pk_bf16_f32 v18, v133, v137
  v_cvt_pk_bf16_f32 v20, v134, v138
  v_cvt_pk_bf16_f32 v22, v135, v139
  v_cvt_pk_bf16_f32 v17, v140, v144
  v_cvt_pk_bf16_f32 v19, v141, v145
  v_cvt_pk_bf16_f32 v21, v142, v146
  v_cvt_pk_bf16_f32 v23, v143, v147
  s_waitcnt lgkmcnt(12)
  ds_write_b128 v168, v[16:19] offset:17024
  ds_write_b128 v168, v[20:23] offset:21120
  s_waitcnt lgkmcnt(0)
  s_barrier
  s_lshl_b32 s68, s3, 1
  s_add_u32 s68, s68, 8
  s_mul_i32 s68, s68, 2752
  s_mul_i32 s69, s24, 384
  s_add_u32 s68, s68, s69
  s_mul_i32 s69, s3, 27008
  s_add_u32 s69, s69, 41856
  ds_read_b128 v[16:19], v169 offset:17024
  ds_read_b128 v[20:23], v169 offset:21120
  s_waitcnt vmcnt(3)
  v_lshlrev_b32 v40, 16, v24
  s_waitcnt vmcnt(2)
  v_lshlrev_b32 v41, 16, v28
  v_and_b32 v42, 0xffff0000, v24
  v_and_b32 v43, 0xffff0000, v28
  v_lshlrev_b32 v44, 16, v25
  v_lshlrev_b32 v45, 16, v29
  s_add_u32 m0, s69, 0
  s_mov_b64 exec, s[8:9]
  buffer_load_dwordx4 v7, s[44:47], s68 offen lds
  s_mov_b64 exec, -1
  s_add_u32 s68, s68, 44032
  v_and_b32 v46, 0xffff0000, v25
  v_and_b32 v47, 0xffff0000, v29
  v_lshlrev_b32 v48, 16, v26
  v_lshlrev_b32 v49, 16, v30
  v_and_b32 v50, 0xffff0000, v26
  v_and_b32 v51, 0xffff0000, v30
  v_lshlrev_b32 v52, 16, v27
  v_lshlrev_b32 v53, 16, v31
  s_add_u32 m0, s69, 832
  s_mov_b64 exec, s[8:9]
  buffer_load_dwordx4 v7, s[44:47], s68 offen lds
  s_mov_b64 exec, -1
  s_add_u32 s68, s68, 44032
  v_and_b32 v54, 0xffff0000, v27
  v_and_b32 v55, 0xffff0000, v31
  s_waitcnt lgkmcnt(1)
  v_mfma_f32_16x16x16_bf16 v[132:135], v[128:129], v[16:17], 0
  v_mfma_f32_16x16x16_bf16 v[136:139], v[128:129], v[18:19], 0
  s_waitcnt lgkmcnt(0)
  v_mfma_f32_16x16x16_bf16 v[140:143], v[128:129], v[20:21], 0
  v_mfma_f32_16x16x16_bf16 v[144:147], v[128:129], v[22:23], 0
  s_nop 3
  v_pk_mul_f32 v[148:149], v[132:133], v[40:41] op_sel:[0,0] op_sel_hi:[1,0]
  v_pk_mul_f32 v[150:151], v[134:135], v[42:43] op_sel:[0,0] op_sel_hi:[1,0]
  s_add_u32 m0, s69, 1664
  s_mov_b64 exec, s[8:9]
  buffer_load_dwordx4 v7, s[44:47], s68 offen lds
  s_mov_b64 exec, -1
  s_add_u32 s68, s68, 44032
  v_pk_mul_f32 v[152:153], v[136:137], v[44:45] op_sel:[0,0] op_sel_hi:[1,0]
  v_pk_mul_f32 v[154:155], v[138:139], v[46:47] op_sel:[0,0] op_sel_hi:[1,0]
  v_pk_mul_f32 v[156:157], v[140:141], v[48:49] op_sel:[0,0] op_sel_hi:[1,0]
  v_pk_mul_f32 v[158:159], v[142:143], v[50:51] op_sel:[0,0] op_sel_hi:[1,0]
  v_pk_mul_f32 v[160:161], v[144:145], v[52:53] op_sel:[0,0] op_sel_hi:[1,0]
  v_pk_mul_f32 v[162:163], v[146:147], v[54:55] op_sel:[0,0] op_sel_hi:[1,0]
  v_pk_fma_f32 v[148:149], v[132:133], v[40:41], v[148:149] op_sel:[1,1,0] op_sel_hi:[0,1,1] neg_lo:[0,1,0]
  v_pk_fma_f32 v[150:151], v[134:135], v[42:43], v[150:151] op_sel:[1,1,0] op_sel_hi:[0,1,1] neg_lo:[0,1,0]
  s_add_u32 m0, s69, 2496
  s_mov_b64 exec, s[8:9]
  buffer_load_dwordx4 v7, s[44:47], s68 offen lds
  s_mov_b64 exec, -1
  s_add_u32 s68, s68, 44032
  v_pk_fma_f32 v[152:153], v[136:137], v[44:45], v[152:153] op_sel:[1,1,0] op_sel_hi:[0,1,1] neg_lo:[0,1,0]
  v_pk_fma_f32 v[154:155], v[138:139], v[46:47], v[154:155] op_sel:[1,1,0] op_sel_hi:[0,1,1] neg_lo:[0,1,0]
  v_pk_fma_f32 v[156:157], v[140:141], v[48:49], v[156:157] op_sel:[1,1,0] op_sel_hi:[0,1,1] neg_lo:[0,1,0]
  v_pk_fma_f32 v[158:159], v[142:143], v[50:51], v[158:159] op_sel:[1,1,0] op_sel_hi:[0,1,1] neg_lo:[0,1,0]
  v_pk_fma_f32 v[160:161], v[144:145], v[52:53], v[160:161] op_sel:[1,1,0] op_sel_hi:[0,1,1] neg_lo:[0,1,0]
  v_pk_fma_f32 v[162:163], v[146:147], v[54:55], v[162:163] op_sel:[1,1,0] op_sel_hi:[0,1,1] neg_lo:[0,1,0]
  s_cmp_lg_u32 s22, 0
  s_cbranch_scc1 sequential_preLN__spectral_gfnet__dense_activation_squared_relu__prompt_kernel_skip2
  s_lshl_b32 s64, s3, 6
  v_lshl_add_u32 v174, v9, 9, v8
  v_add_u32 v174, s64, v174
  v_lshlrev_b32 v173, 3, v174
  ds_write_b64 v173, v[132:133] offset:25472
  ds_write_b64 v173, v[134:135] offset:27520
  ds_write_b64 v173, v[136:137] offset:25600
  ds_write_b64 v173, v[138:139] offset:27648
  ds_write_b64 v173, v[140:141] offset:25728
  ds_write_b64 v173, v[142:143] offset:27776
  ds_write_b64 v173, v[144:145] offset:25856
  ds_write_b64 v173, v[146:147] offset:27904
  v_sub_u32 v184, 2048, v174
  v_and_b32 v184, 2047, v184
  v_lshlrev_b32 v184, 3, v184
  v_sub_u32 v185, 1792, v174
  v_and_b32 v185, 2047, v185
  v_lshlrev_b32 v185, 3, v185
  v_sub_u32 v186, 2032, v174
  v_and_b32 v186, 2047, v186
  v_lshlrev_b32 v186, 3, v186
  v_sub_u32 v187, 1776, v174
  v_and_b32 v187, 2047, v187
  v_lshlrev_b32 v187, 3, v187
  v_sub_u32 v188, 2016, v174
  v_and_b32 v188, 2047, v188
  v_lshlrev_b32 v188, 3, v188
  v_sub_u32 v189, 1760, v174
  v_and_b32 v189, 2047, v189
  v_lshlrev_b32 v189, 3, v189
  v_sub_u32 v190, 2000, v174
  v_and_b32 v190, 2047, v190
  v_lshlrev_b32 v190, 3, v190
  v_sub_u32 v191, 1744, v174
  v_and_b32 v191, 2047, v191
  v_lshlrev_b32 v191, 3, v191
  s_waitcnt lgkmcnt(0)
  s_barrier
  ds_read_b64 v[192:193], v184 offset:25472
  ds_read_b64 v[194:195], v185 offset:25472
  ds_read_b64 v[196:197], v186 offset:25472
  ds_read_b64 v[198:199], v187 offset:25472
  ds_read_b64 v[200:201], v188 offset:25472
  ds_read_b64 v[202:203], v189 offset:25472
  ds_read_b64 v[204:205], v190 offset:25472
  ds_read_b64 v[206:207], v191 offset:25472
  s_waitcnt vmcnt(5)
  v_lshlrev_b32 v208, 16, v176
  s_waitcnt vmcnt(4)
  v_lshlrev_b32 v209, 16, v180
  v_and_b32 v210, 0xffff0000, v176
  v_and_b32 v211, 0xffff0000, v180
  v_lshlrev_b32 v212, 16, v177
  v_lshlrev_b32 v213, 16, v181
  v_and_b32 v214, 0xffff0000, v177
  v_and_b32 v215, 0xffff0000, v181
  v_lshlrev_b32 v216, 16, v178
  v_lshlrev_b32 v217, 16, v182
  v_and_b32 v218, 0xffff0000, v178
  v_and_b32 v219, 0xffff0000, v182
  v_lshlrev_b32 v220, 16, v179
  v_lshlrev_b32 v221, 16, v183
  v_and_b32 v222, 0xffff0000, v179
  v_and_b32 v223, 0xffff0000, v183
  s_waitcnt lgkmcnt(0)
  s_barrier
  v_pk_add_f32 v[224:225], v[132:133], v[192:193] neg_hi:[0,1]
  v_pk_add_f32 v[226:227], v[132:133], v[192:193] neg_lo:[0,1]
  v_pk_mul_f32 v[132:133], v[224:225], v[40:41] op_sel:[0,0] op_sel_hi:[1,0]
  v_pk_mul_f32 v[192:193], v[226:227], v[208:209] op_sel:[0,0] op_sel_hi:[1,0]
  v_pk_fma_f32 v[132:133], v[224:225], v[40:41], v[132:133] op_sel:[1,1,0] op_sel_hi:[0,1,1] neg_lo:[0,1,0]
  v_pk_fma_f32 v[192:193], v[226:227], v[208:209], v[192:193] op_sel:[1,1,0] op_sel_hi:[0,1,1] neg_lo:[0,1,0]
  v_pk_add_f32 v[148:149], v[132:133], v[192:193]
  v_pk_add_f32 v[132:133], v[132:133], v[192:193] neg_lo:[0,1] neg_hi:[0,1]
  ds_write_b64 v173, v[132:133] offset:25472
  v_pk_add_f32 v[224:225], v[134:135], v[194:195] neg_hi:[0,1]
  v_pk_add_f32 v[226:227], v[134:135], v[194:195] neg_lo:[0,1]
  v_pk_mul_f32 v[134:135], v[224:225], v[42:43] op_sel:[0,0] op_sel_hi:[1,0]
  v_pk_mul_f32 v[194:195], v[226:227], v[210:211] op_sel:[0,0] op_sel_hi:[1,0]
  v_pk_fma_f32 v[134:135], v[224:225], v[42:43], v[134:135] op_sel:[1,1,0] op_sel_hi:[0,1,1] neg_lo:[0,1,0]
  v_pk_fma_f32 v[194:195], v[226:227], v[210:211], v[194:195] op_sel:[1,1,0] op_sel_hi:[0,1,1] neg_lo:[0,1,0]
  v_pk_add_f32 v[150:151], v[134:135], v[194:195]
  v_pk_add_f32 v[134:135], v[134:135], v[194:195] neg_lo:[0,1] neg_hi:[0,1]
  ds_write_b64 v173, v[134:135] offset:27520
  v_pk_add_f32 v[224:225], v[136:137], v[196:197] neg_hi:[0,1]
  v_pk_add_f32 v[226:227], v[136:137], v[196:197] neg_lo:[0,1]
  v_pk_mul_f32 v[136:137], v[224:225], v[44:45] op_sel:[0,0] op_sel_hi:[1,0]
  v_pk_mul_f32 v[196:197], v[226:227], v[212:213] op_sel:[0,0] op_sel_hi:[1,0]
  v_pk_fma_f32 v[136:137], v[224:225], v[44:45], v[136:137] op_sel:[1,1,0] op_sel_hi:[0,1,1] neg_lo:[0,1,0]
  v_pk_fma_f32 v[196:197], v[226:227], v[212:213], v[196:197] op_sel:[1,1,0] op_sel_hi:[0,1,1] neg_lo:[0,1,0]
  v_pk_add_f32 v[152:153], v[136:137], v[196:197]
  v_pk_add_f32 v[136:137], v[136:137], v[196:197] neg_lo:[0,1] neg_hi:[0,1]
  ds_write_b64 v173, v[136:137] offset:25600
  v_pk_add_f32 v[224:225], v[138:139], v[198:199] neg_hi:[0,1]
  v_pk_add_f32 v[226:227], v[138:139], v[198:199] neg_lo:[0,1]
  v_pk_mul_f32 v[138:139], v[224:225], v[46:47] op_sel:[0,0] op_sel_hi:[1,0]
  v_pk_mul_f32 v[198:199], v[226:227], v[214:215] op_sel:[0,0] op_sel_hi:[1,0]
  v_pk_fma_f32 v[138:139], v[224:225], v[46:47], v[138:139] op_sel:[1,1,0] op_sel_hi:[0,1,1] neg_lo:[0,1,0]
  v_pk_fma_f32 v[198:199], v[226:227], v[214:215], v[198:199] op_sel:[1,1,0] op_sel_hi:[0,1,1] neg_lo:[0,1,0]
  v_pk_add_f32 v[154:155], v[138:139], v[198:199]
  v_pk_add_f32 v[138:139], v[138:139], v[198:199] neg_lo:[0,1] neg_hi:[0,1]
  ds_write_b64 v173, v[138:139] offset:27648
  v_pk_add_f32 v[224:225], v[140:141], v[200:201] neg_hi:[0,1]
  v_pk_add_f32 v[226:227], v[140:141], v[200:201] neg_lo:[0,1]
  v_pk_mul_f32 v[140:141], v[224:225], v[48:49] op_sel:[0,0] op_sel_hi:[1,0]
  v_pk_mul_f32 v[200:201], v[226:227], v[216:217] op_sel:[0,0] op_sel_hi:[1,0]
  v_pk_fma_f32 v[140:141], v[224:225], v[48:49], v[140:141] op_sel:[1,1,0] op_sel_hi:[0,1,1] neg_lo:[0,1,0]
  v_pk_fma_f32 v[200:201], v[226:227], v[216:217], v[200:201] op_sel:[1,1,0] op_sel_hi:[0,1,1] neg_lo:[0,1,0]
  v_pk_add_f32 v[156:157], v[140:141], v[200:201]
  v_pk_add_f32 v[140:141], v[140:141], v[200:201] neg_lo:[0,1] neg_hi:[0,1]
  ds_write_b64 v173, v[140:141] offset:25728
  v_pk_add_f32 v[224:225], v[142:143], v[202:203] neg_hi:[0,1]
  v_pk_add_f32 v[226:227], v[142:143], v[202:203] neg_lo:[0,1]
  v_pk_mul_f32 v[142:143], v[224:225], v[50:51] op_sel:[0,0] op_sel_hi:[1,0]
  v_pk_mul_f32 v[202:203], v[226:227], v[218:219] op_sel:[0,0] op_sel_hi:[1,0]
  v_pk_fma_f32 v[142:143], v[224:225], v[50:51], v[142:143] op_sel:[1,1,0] op_sel_hi:[0,1,1] neg_lo:[0,1,0]
  v_pk_fma_f32 v[202:203], v[226:227], v[218:219], v[202:203] op_sel:[1,1,0] op_sel_hi:[0,1,1] neg_lo:[0,1,0]
  v_pk_add_f32 v[158:159], v[142:143], v[202:203]
  v_pk_add_f32 v[142:143], v[142:143], v[202:203] neg_lo:[0,1] neg_hi:[0,1]
  ds_write_b64 v173, v[142:143] offset:27776
  v_pk_add_f32 v[224:225], v[144:145], v[204:205] neg_hi:[0,1]
  v_pk_add_f32 v[226:227], v[144:145], v[204:205] neg_lo:[0,1]
  v_pk_mul_f32 v[144:145], v[224:225], v[52:53] op_sel:[0,0] op_sel_hi:[1,0]
  v_pk_mul_f32 v[204:205], v[226:227], v[220:221] op_sel:[0,0] op_sel_hi:[1,0]
  v_pk_fma_f32 v[144:145], v[224:225], v[52:53], v[144:145] op_sel:[1,1,0] op_sel_hi:[0,1,1] neg_lo:[0,1,0]
  v_pk_fma_f32 v[204:205], v[226:227], v[220:221], v[204:205] op_sel:[1,1,0] op_sel_hi:[0,1,1] neg_lo:[0,1,0]
  v_pk_add_f32 v[160:161], v[144:145], v[204:205]
  v_pk_add_f32 v[144:145], v[144:145], v[204:205] neg_lo:[0,1] neg_hi:[0,1]
  ds_write_b64 v173, v[144:145] offset:25856
  v_pk_add_f32 v[224:225], v[146:147], v[206:207] neg_hi:[0,1]
  v_pk_add_f32 v[226:227], v[146:147], v[206:207] neg_lo:[0,1]
  v_pk_mul_f32 v[146:147], v[224:225], v[54:55] op_sel:[0,0] op_sel_hi:[1,0]
  v_pk_mul_f32 v[206:207], v[226:227], v[222:223] op_sel:[0,0] op_sel_hi:[1,0]
  v_pk_fma_f32 v[146:147], v[224:225], v[54:55], v[146:147] op_sel:[1,1,0] op_sel_hi:[0,1,1] neg_lo:[0,1,0]
  v_pk_fma_f32 v[206:207], v[226:227], v[222:223], v[206:207] op_sel:[1,1,0] op_sel_hi:[0,1,1] neg_lo:[0,1,0]
  v_pk_add_f32 v[162:163], v[146:147], v[206:207]
  v_pk_add_f32 v[146:147], v[146:147], v[206:207] neg_lo:[0,1] neg_hi:[0,1]
  ds_write_b64 v173, v[146:147] offset:27904
  s_waitcnt lgkmcnt(0)
  s_barrier
  ds_read_b64 v[192:193], v184 offset:25472
  ds_read_b64 v[194:195], v185 offset:25472
  ds_read_b64 v[196:197], v186 offset:25472
  ds_read_b64 v[198:199], v187 offset:25472
  ds_read_b64 v[200:201], v188 offset:25472
  ds_read_b64 v[202:203], v189 offset:25472
  ds_read_b64 v[204:205], v190 offset:25472
  ds_read_b64 v[206:207], v191 offset:25472
  v_mov_b32 v224, 0x3e800000
  s_waitcnt lgkmcnt(7)
  v_pk_add_f32 v[148:149], v[148:149], v[192:193] neg_hi:[0,1]
  v_pk_mul_f32 v[148:149], v[148:149], v[224:225] op_sel_hi:[1,0]
  s_waitcnt lgkmcnt(6)
  v_pk_add_f32 v[150:151], v[150:151], v[194:195] neg_hi:[0,1]
  v_pk_mul_f32 v[150:151], v[150:151], v[224:225] op_sel_hi:[1,0]
  s_waitcnt lgkmcnt(5)
  v_pk_add_f32 v[152:153], v[152:153], v[196:197] neg_hi:[0,1]
  v_pk_mul_f32 v[152:153], v[152:153], v[224:225] op_sel_hi:[1,0]
  s_waitcnt lgkmcnt(4)
  v_pk_add_f32 v[154:155], v[154:155], v[198:199] neg_hi:[0,1]
  v_pk_mul_f32 v[154:155], v[154:155], v[224:225] op_sel_hi:[1,0]
  s_waitcnt lgkmcnt(3)
  v_pk_add_f32 v[156:157], v[156:157], v[200:201] neg_hi:[0,1]
  v_pk_mul_f32 v[156:157], v[156:157], v[224:225] op_sel_hi:[1,0]
  s_waitcnt lgkmcnt(2)
  v_pk_add_f32 v[158:159], v[158:159], v[202:203] neg_hi:[0,1]
  v_pk_mul_f32 v[158:159], v[158:159], v[224:225] op_sel_hi:[1,0]
  s_waitcnt lgkmcnt(1)
  v_pk_add_f32 v[160:161], v[160:161], v[204:205] neg_hi:[0,1]
  v_pk_mul_f32 v[160:161], v[160:161], v[224:225] op_sel_hi:[1,0]
  s_waitcnt lgkmcnt(0)
  v_pk_add_f32 v[162:163], v[162:163], v[206:207] neg_hi:[0,1]
  v_pk_mul_f32 v[162:163], v[162:163], v[224:225] op_sel_hi:[1,0]
sequential_preLN__spectral_gfnet__dense_activation_squared_relu__prompt_kernel_skip2:
  v_cvt_pk_bf16_f32 v16, v148, v149
  v_cvt_pk_bf16_f32 v17, v150, v151
  s_add_u32 m0, s69, 3328
  s_mov_b64 exec, s[8:9]
  buffer_load_dwordx4 v7, s[44:47], s68 offen lds
  s_mov_b64 exec, -1
  s_add_u32 s68, s68, 44032
  v_cvt_pk_bf16_f32 v18, v152, v153
  v_cvt_pk_bf16_f32 v19, v154, v155
  v_cvt_pk_bf16_f32 v20, v156, v157
  v_cvt_pk_bf16_f32 v21, v158, v159
  v_cvt_pk_bf16_f32 v22, v160, v161
  v_cvt_pk_bf16_f32 v23, v162, v163
  v_mfma_f32_16x16x16_bf16 v[132:135], v[130:131], v[16:17], 0
  v_mfma_f32_16x16x16_bf16 v[136:139], v[130:131], v[18:19], 0
  s_add_u32 m0, s69, 4160
  s_mov_b64 exec, s[8:9]
  buffer_load_dwordx4 v7, s[44:47], s68 offen lds
  s_mov_b64 exec, -1
  s_add_u32 s68, s68, 44032
  v_mfma_f32_16x16x16_bf16 v[140:143], v[130:131], v[20:21], 0
  v_mfma_f32_16x16x16_bf16 v[144:147], v[130:131], v[22:23], 0
  v_cvt_pk_bf16_f32 v24, v132, v133
  v_cvt_pk_bf16_f32 v28, v134, v135
  v_cvt_pk_bf16_f32 v25, v136, v137
  v_cvt_pk_bf16_f32 v29, v138, v139
  s_nop 2
  v_cvt_pk_bf16_f32 v26, v140, v141
  v_cvt_pk_bf16_f32 v30, v142, v143
  s_add_u32 m0, s69, 4992
  s_mov_b64 exec, s[8:9]
  buffer_load_dwordx4 v7, s[44:47], s68 offen lds
  s_mov_b64 exec, -1
  s_add_u32 s68, s68, 44032
  v_cvt_pk_bf16_f32 v27, v144, v145
  v_cvt_pk_bf16_f32 v31, v146, v147
  ds_write_b128 v168, v[24:27] offset:8320
  ds_write_b128 v168, v[28:31] offset:12416
  s_waitcnt lgkmcnt(0)
  s_barrier
  ds_read_b128 v[16:19], v169 offset:8320
  ds_read_b128 v[20:23], v169 offset:12416
  s_waitcnt lgkmcnt(1)
  v_mfma_f32_16x16x32_bf16 v[132:135], v[16:19], v[88:91], 0
  s_add_u32 m0, s69, 5824
  s_mov_b64 exec, s[8:9]
  buffer_load_dwordx4 v7, s[44:47], s68 offen lds
  s_mov_b64 exec, -1
  s_add_u32 s68, s68, 44032
  v_mfma_f32_16x16x32_bf16 v[136:139], v[16:19], v[92:95], 0
  s_waitcnt lgkmcnt(0)
  v_mfma_f32_16x16x32_bf16 v[140:143], v[20:23], v[96:99], 0
  v_mfma_f32_16x16x32_bf16 v[144:147], v[20:23], v[100:103], 0
  v_pk_mul_f32 v[156:157], v[132:133], v[120:121]
  s_nop 3
  v_pk_mul_f32 v[148:149], v[136:137], v[120:121]
  v_pk_fma_f32 v[156:157], v[136:137], v[124:125], v[156:157] neg_lo:[0,1,0] neg_hi:[0,1,0]
  v_pk_fma_f32 v[148:149], v[132:133], v[124:125], v[148:149]
  v_pk_mul_f32 v[158:159], v[134:135], v[122:123]
  s_add_u32 m0, s69, 6656
  s_mov_b64 exec, s[8:9]
  buffer_load_dwordx4 v7, s[44:47], s68 offen lds
  s_mov_b64 exec, -1
  s_add_u32 s68, s68, 44032
  v_pk_mul_f32 v[150:151], v[138:139], v[122:123]
  v_pk_fma_f32 v[158:159], v[138:139], v[126:127], v[158:159] neg_lo:[0,1,0] neg_hi:[0,1,0]
  v_pk_fma_f32 v[150:151], v[134:135], v[126:127], v[150:151]
  v_cvt_pk_bf16_f32 v16, v156, v148
  v_cvt_pk_bf16_f32 v17, v157, v149
  v_cvt_pk_bf16_f32 v18, v158, v150
  v_cvt_pk_bf16_f32 v19, v159, v151
  v_pk_mul_f32 v[160:161], v[140:141], v[120:121]
  s_add_u32 m0, s69, 7488
  s_mov_b64 exec, s[8:9]
  buffer_load_dwordx4 v7, s[44:47], s68 offen lds
  s_mov_b64 exec, -1
  s_add_u32 s68, s68, 44032
  v_pk_mul_f32 v[152:153], v[144:145], v[120:121]
  v_pk_fma_f32 v[160:161], v[144:145], v[124:125], v[160:161] neg_lo:[0,1,0] neg_hi:[0,1,0]
  v_pk_fma_f32 v[152:153], v[140:141], v[124:125], v[152:153]
  v_pk_mul_f32 v[162:163], v[142:143], v[122:123]
  v_pk_mul_f32 v[154:155], v[146:147], v[122:123]
  v_pk_fma_f32 v[162:163], v[146:147], v[126:127], v[162:163] neg_lo:[0,1,0] neg_hi:[0,1,0]
  v_pk_fma_f32 v[154:155], v[142:143], v[126:127], v[154:155]
  v_cvt_pk_bf16_f32 v20, v160, v152
  s_add_u32 m0, s69, 8320
  s_mov_b64 exec, s[8:9]
  buffer_load_dwordx4 v7, s[44:47], s68 offen lds
  s_mov_b64 exec, -1
  s_add_u32 s68, s68, 44032
  v_cvt_pk_bf16_f32 v21, v161, v153
  v_cvt_pk_bf16_f32 v22, v162, v154
  v_cvt_pk_bf16_f32 v23, v163, v155
  v_mfma_f32_16x16x32_bf16 v[132:135], v[104:107], v[16:19], 0
  v_mfma_f32_16x16x32_bf16 v[136:139], v[108:111], v[16:19], 0
  v_mfma_f32_16x16x32_bf16 v[140:143], v[112:115], v[20:23], 0
  v_mfma_f32_16x16x32_bf16 v[144:147], v[116:119], v[20:23], 0
  s_nop 5
  v_cvt_pk_bf16_f32 v224, v132, v136
  s_add_u32 m0, s69, 9152
  s_mov_b64 exec, s[8:9]
  buffer_load_dwordx4 v7, s[44:47], s68 offen lds
  s_mov_b64 exec, -1
  s_add_u32 s68, s68, 44032
  v_cvt_pk_bf16_f32 v225, v133, v137
  v_cvt_pk_bf16_f32 v226, v134, v138
  v_cvt_pk_bf16_f32 v227, v135, v139
  buffer_store_dwordx4 v[224:227], v170, s[28:31], s60 offen sc1
  v_cvt_pk_bf16_f32 v228, v140, v144
  v_cvt_pk_bf16_f32 v229, v141, v145
  v_cvt_pk_bf16_f32 v230, v142, v146
  v_cvt_pk_bf16_f32 v231, v143, v147
  buffer_store_dwordx4 v[228:231], v170, s[28:31], s61 offen sc1
  v_mul_u32_u24 v28, 1040, v10
  v_lshl_add_u32 v28, v9, 7, v28
  v_lshl_add_u32 v28, v11, 2, v28
  s_lshl_b32 s56, s3, 3
  v_add_u32 v28, s56, v28
  ds_read_b32 v208, v28 offset:0
  ds_read_b32 v209, v28 offset:32
  ds_read_b32 v210, v28 offset:64
  ds_read_b32 v211, v28 offset:96
  ds_read_b32 v212, v28 offset:512
  ds_read_b32 v213, v28 offset:544
  ds_read_b32 v214, v28 offset:576
  ds_read_b32 v215, v28 offset:608
  s_mov_b32 s36, s14
  s_mov_b32 s37, s15
  s_mov_b32 s38, 2752
  s_mov_b32 s39, 0x20000
  s_mov_b32 s40, s18
  s_mov_b32 s41, s19
  s_mov_b32 s42, 1024
  s_mov_b32 s43, 0x20000
  v_cvt_f32_u32 v248, v8
  v_lshlrev_b32 v249, 2, v9
  v_cvt_f32_u32 v249, v249
  v_mul_f32 v250, 0x3d800000, v248
  v_cmp_lt_u32 vcc, 1, v9
  v_mov_b32 v251, 0x80000000
  v_mul_f32 v240, v249, v250
  v_cndmask_b32 v251, 0, v251, vcc
  s_add_u32 m0, s69, 9984
  s_mov_b64 exec, s[8:9]
  buffer_load_dwordx4 v7, s[44:47], s68 offen lds
  s_mov_b64 exec, -1
  s_add_u32 s68, s68, 44032
  v_add_f32 v242, v240, v250
  v_add_f32 v244, v242, v250
  v_add_f32 v246, v244, v250
  v_sin_f32 v241, v240
  v_cos_f32 v240, v240
  v_sin_f32 v243, v242
  v_cos_f32 v242, v242
  v_sin_f32 v245, v244
  s_add_u32 m0, s69, 10816
  s_mov_b64 exec, s[8:9]
  buffer_load_dwordx4 v7, s[44:47], s68 offen lds
  s_mov_b64 exec, -1
  s_add_u32 s68, s68, 44032
  v_cos_f32 v244, v244
  v_sin_f32 v247, v246
  v_cos_f32 v246, v246
  v_cvt_pk_bf16_f32 v144, v240, -v241
  v_cvt_pk_bf16_f32 v148, v241, v240
  v_xor_b32 v144, v251, v144
  v_xor_b32 v148, v251, v148
  v_cvt_pk_bf16_f32 v145, v242, -v243
  s_add_u32 m0, s69, 11648
  s_mov_b64 exec, s[8:9]
  buffer_load_dwordx4 v7, s[44:47], s68 offen lds
  s_mov_b64 exec, -1
  s_add_u32 s68, s68, 44032
  v_cvt_pk_bf16_f32 v149, v243, v242
  v_xor_b32 v145, v251, v145
  v_xor_b32 v149, v251, v149
  v_cvt_pk_bf16_f32 v146, v244, -v245
  v_cvt_pk_bf16_f32 v150, v245, v244
  v_xor_b32 v146, v251, v146
  v_xor_b32 v150, v251, v150
  v_cvt_pk_bf16_f32 v147, v246, -v247
  s_add_u32 m0, s69, 12480
  s_mov_b64 exec, s[8:9]
  buffer_load_dwordx4 v7, s[44:47], s68 offen lds
  s_mov_b64 exec, -1
  s_add_u32 s68, s68, 44032
  v_cvt_pk_bf16_f32 v151, v247, v246
  v_xor_b32 v147, v251, v147
  v_xor_b32 v151, v251, v151
  s_lshl_b32 s56, s3, 2
  v_cvt_f32_u32 v250, s56
  v_fmac_f32 v250, 0x41800000, v248
  v_mul_f32 v250, 0x3b000000, v250
  v_mul_f32 v254, 0.5, v248
  s_add_u32 m0, s69, 13504
  s_mov_b64 exec, s[8:9]
  buffer_load_dwordx4 v7, s[44:47], s68 offen lds
  s_mov_b64 exec, -1
  s_add_u32 s68, s68, 44032
  v_mov_b32 v255, 0x3e800000
  v_cmp_eq_u32 vcc, 0, v9
  s_nop 1
  v_cndmask_b32 v254, v255, v254, vcc
  v_add_f32 v251, 0x00000000, v250
  v_mul_f32 v240, v249, v251
  v_add_f32 v241, v240, v254
  v_add_f32 v242, v240, v251
  v_cos_f32 v240, v240
  s_add_u32 m0, s69, 14336
  s_mov_b64 exec, s[8:9]
  buffer_load_dwordx4 v7, s[44:47], s68 offen lds
  s_mov_b64 exec, -1
  s_add_u32 s68, s68, 44032
  v_cos_f32 v241, v241
  v_add_f32 v244, v242, v251
  v_sin_f32 v243, v242
  v_cos_f32 v242, v242
  v_add_f32 v246, v244, v251
  v_sin_f32 v245, v244
  v_cos_f32 v244, v244
  v_cvt_pk_bf16_f32 v160, v240, v241
  s_add_u32 m0, s69, 15168
  s_mov_b64 exec, s[8:9]
  buffer_load_dwordx4 v7, s[44:47], s68 offen lds
  s_mov_b64 exec, -1
  s_add_u32 s68, s68, 44032
  v_sin_f32 v247, v246
  v_cos_f32 v246, v246
  v_cvt_pk_bf16_f32 v161, v242, -v243
  v_cvt_pk_bf16_f32 v162, v244, -v245
  v_cvt_pk_bf16_f32 v163, v246, -v247
  v_add_f32 v251, 0x3f000000, v250
  v_mul_f32 v240, v249, v251
  v_add_f32 v241, v240, v254
  s_add_u32 m0, s69, 16000
  s_mov_b64 exec, s[8:9]
  buffer_load_dwordx4 v7, s[44:47], s68 offen lds
  s_mov_b64 exec, -1
  s_add_u32 s68, s68, 44032
  v_add_f32 v242, v240, v251
  v_cos_f32 v240, v240
  v_cos_f32 v241, v241
  v_add_f32 v244, v242, v251
  v_sin_f32 v243, v242
  v_cos_f32 v242, v242
  v_add_f32 v246, v244, v251
  v_sin_f32 v245, v244
  s_add_u32 m0, s69, 16832
  s_mov_b64 exec, s[8:9]
  buffer_load_dwordx4 v7, s[44:47], s68 offen lds
  s_mov_b64 exec, -1
  s_add_u32 s68, s68, 44032
  v_cos_f32 v244, v244
  v_cvt_pk_bf16_f32 v164, v240, v241
  v_sin_f32 v247, v246
  v_cos_f32 v246, v246
  v_cvt_pk_bf16_f32 v165, v242, -v243
  v_cvt_pk_bf16_f32 v166, v244, -v245
  v_cvt_pk_bf16_f32 v167, v246, -v247
  v_add_f32 v251, 0x3b000000, v250
  s_add_u32 m0, s69, 17664
  s_mov_b64 exec, s[8:9]
  buffer_load_dwordx4 v7, s[44:47], s68 offen lds
  s_mov_b64 exec, -1
  s_add_u32 s68, s68, 44032
  v_mul_f32 v240, v249, v251
  v_add_f32 v241, v240, v254
  v_add_f32 v242, v240, v251
  v_cos_f32 v240, v240
  v_cos_f32 v241, v241
  v_add_f32 v244, v242, v251
  v_sin_f32 v243, v242
  v_cos_f32 v242, v242
  s_add_u32 m0, s69, 18496
  s_mov_b64 exec, s[8:9]
  buffer_load_dwordx4 v7, s[44:47], s68 offen lds
  s_mov_b64 exec, -1
  s_add_u32 s68, s68, 44032
  v_add_f32 v246, v244, v251
  v_sin_f32 v245, v244
  v_cos_f32 v244, v244
  v_cvt_pk_bf16_f32 v168, v240, v241
  v_sin_f32 v247, v246
  v_cos_f32 v246, v246
  v_cvt_pk_bf16_f32 v169, v242, -v243
  v_cvt_pk_bf16_f32 v170, v244, -v245
  s_add_u32 m0, s69, 19328
  s_mov_b64 exec, s[8:9]
  buffer_load_dwordx4 v7, s[44:47], s68 offen lds
  s_mov_b64 exec, -1
  s_add_u32 s68, s68, 44032
  v_cvt_pk_bf16_f32 v171, v246, -v247
  v_add_f32 v251, 0x3f008000, v250
  v_mul_f32 v240, v249, v251
  v_add_f32 v241, v240, v254
  v_add_f32 v242, v240, v251
  v_cos_f32 v240, v240
  v_cos_f32 v241, v241
  v_add_f32 v244, v242, v251
  s_add_u32 m0, s69, 20160
  s_mov_b64 exec, s[8:9]
  buffer_load_dwordx4 v7, s[44:47], s68 offen lds
  s_mov_b64 exec, -1
  s_add_u32 s68, s68, 44032
  v_sin_f32 v243, v242
  v_cos_f32 v242, v242
  v_add_f32 v246, v244, v251
  v_sin_f32 v245, v244
  v_cos_f32 v244, v244
  v_cvt_pk_bf16_f32 v172, v240, v241
  v_sin_f32 v247, v246
  v_cos_f32 v246, v246
  s_add_u32 m0, s69, 20992
  s_mov_b64 exec, s[8:9]
  buffer_load_dwordx4 v7, s[44:47], s68 offen lds
  s_mov_b64 exec, -1
  s_add_u32 s68, s68, 44032
  v_cvt_pk_bf16_f32 v173, v242, -v243
  v_cvt_pk_bf16_f32 v174, v244, -v245
  v_cvt_pk_bf16_f32 v175, v246, -v247
  v_add_f32 v251, 0x3b800000, v250
  v_mul_f32 v240, v249, v251
  v_add_f32 v241, v240, v254
  v_add_f32 v242, v240, v251
  v_cos_f32 v240, v240
  s_add_u32 m0, s69, 21824
  s_mov_b64 exec, s[8:9]
  buffer_load_dwordx4 v7, s[44:47], s68 offen lds
  s_mov_b64 exec, -1
  s_add_u32 s68, s68, 44032
  v_cos_f32 v241, v241
  v_add_f32 v244, v242, v251
  v_sin_f32 v243, v242
  v_cos_f32 v242, v242
  v_add_f32 v246, v244, v251
  v_sin_f32 v245, v244
  v_cos_f32 v244, v244
  s_waitcnt vmcnt(30)
  v_cvt_pk_bf16_f32 v176, v240, v241
  s_add_u32 m0, s69, 22656
  s_mov_b64 exec, s[8:9]
  buffer_load_dwordx4 v7, s[44:47], s68 offen lds
  s_mov_b64 exec, -1
  s_add_u32 s68, s68, 44032
  v_sin_f32 v247, v246
  v_cos_f32 v246, v246
  v_cvt_pk_bf16_f32 v177, v242, -v243
  v_cvt_pk_bf16_f32 v178, v244, -v245
  v_cvt_pk_bf16_f32 v179, v246, -v247
  v_add_f32 v251, 0x3f010000, v250
  v_mul_f32 v240, v249, v251
  v_add_f32 v241, v240, v254
  s_add_u32 m0, s69, 23488
  s_mov_b64 exec, s[8:9]
  buffer_load_dwordx4 v7, s[44:47], s68 offen lds
  s_mov_b64 exec, -1
  s_add_u32 s68, s68, 44032
  v_add_f32 v242, v240, v251
  v_cos_f32 v240, v240
  v_cos_f32 v241, v241
  v_add_f32 v244, v242, v251
  v_sin_f32 v243, v242
  v_cos_f32 v242, v242
  v_add_f32 v246, v244, v251
  v_sin_f32 v245, v244
  s_add_u32 m0, s69, 24320
  s_mov_b64 exec, s[8:9]
  buffer_load_dwordx4 v7, s[44:47], s68 offen lds
  s_mov_b64 exec, -1
  s_add_u32 s68, s68, 44032
  v_cos_f32 v244, v244
  s_waitcnt vmcnt(32)
  v_cvt_pk_bf16_f32 v180, v240, v241
  v_sin_f32 v247, v246
  v_cos_f32 v246, v246
  v_cvt_pk_bf16_f32 v181, v242, -v243
  v_cvt_pk_bf16_f32 v182, v244, -v245
  v_cvt_pk_bf16_f32 v183, v246, -v247
  v_add_f32 v251, 0x3bc00000, v250
  s_add_u32 m0, s69, 25152
  s_mov_b64 exec, s[8:9]
  buffer_load_dwordx4 v7, s[44:47], s68 offen lds
  s_mov_b64 exec, -1
  s_add_u32 s68, s68, 44032
  v_mul_f32 v240, v249, v251
  v_add_f32 v241, v240, v254
  v_add_f32 v242, v240, v251
  v_cos_f32 v240, v240
  v_cos_f32 v241, v241
  v_add_f32 v244, v242, v251
  v_sin_f32 v243, v242
  v_cos_f32 v242, v242
  s_add_u32 m0, s69, 25984
  s_mov_b64 exec, s[8:9]
  buffer_load_dwordx4 v7, s[44:47], s68 offen lds
  s_mov_b64 exec, -1
  s_add_u32 s68, s68, 44032
  v_add_f32 v246, v244, v251
  v_sin_f32 v245, v244
  v_cos_f32 v244, v244
  v_cvt_pk_bf16_f32 v184, v240, v241
  v_sin_f32 v247, v246
  v_cos_f32 v246, v246
  v_cvt_pk_bf16_f32 v185, v242, -v243
  v_cvt_pk_bf16_f32 v186, v244, -v245
  v_cvt_pk_bf16_f32 v187, v246, -v247
  v_add_f32 v251, 0x3f018000, v250
  v_mul_f32 v240, v249, v251
  v_add_f32 v241, v240, v254
  v_add_f32 v242, v240, v251
  v_cos_f32 v240, v240
  v_cos_f32 v241, v241
  v_add_f32 v244, v242, v251
  v_sin_f32 v243, v242
  v_cos_f32 v242, v242
  v_add_f32 v246, v244, v251
  v_sin_f32 v245, v244
  v_cos_f32 v244, v244
  v_cvt_pk_bf16_f32 v188, v240, v241
  v_sin_f32 v247, v246
  v_cos_f32 v246, v246
  v_cvt_pk_bf16_f32 v189, v242, -v243
  v_cvt_pk_bf16_f32 v190, v244, -v245
  v_cvt_pk_bf16_f32 v191, v246, -v247
  v_mov_b32 v128, 0
  v_mov_b32 v129, 0
  v_mov_b32 v130, 0
  v_mov_b32 v131, 0
  v_mov_b32 v132, 0
  v_mov_b32 v133, 0
  v_mov_b32 v134, 0
  v_mov_b32 v135, 0
  v_mov_b32 v136, 0
  v_mov_b32 v137, 0
  v_mov_b32 v138, 0
  v_mov_b32 v139, 0
  v_mov_b32 v140, 0
  v_mov_b32 v141, 0
  v_mov_b32 v142, 0
  v_mov_b32 v143, 0
  s_waitcnt lgkmcnt(7)
  v_lshlrev_b32 v192, 16, v208
  v_and_b32 v200, 0xffff0000, v208
  s_waitcnt lgkmcnt(6)
  v_lshlrev_b32 v193, 16, v209
  v_and_b32 v201, 0xffff0000, v209
  s_waitcnt lgkmcnt(5)
  v_lshlrev_b32 v194, 16, v210
  v_and_b32 v202, 0xffff0000, v210
  s_waitcnt lgkmcnt(4)
  v_lshlrev_b32 v195, 16, v211
  v_and_b32 v203, 0xffff0000, v211
  s_waitcnt lgkmcnt(3)
  v_lshlrev_b32 v196, 16, v212
  v_and_b32 v204, 0xffff0000, v212
  s_waitcnt lgkmcnt(2)
  v_lshlrev_b32 v197, 16, v213
  v_and_b32 v205, 0xffff0000, v213
  s_waitcnt lgkmcnt(1)
  v_lshlrev_b32 v198, 16, v214
  v_and_b32 v206, 0xffff0000, v214
  s_waitcnt lgkmcnt(0)
  v_lshlrev_b32 v199, 16, v215
  v_and_b32 v207, 0xffff0000, v215
  v_lshlrev_b32 v28, 13, v11
  v_lshl_add_u32 v28, v9, 10, v28
  v_lshl_add_u32 v28, v10, 2, v28
  s_lshl_b32 s62, s23, 18
  s_add_u32 s62, s62, 1048576
  s_lshl_b32 s56, s3, 14
  s_add_u32 s56, s56, s62
  s_lshl_b32 s57, s24, 5
  s_add_u32 s56, s56, s57
  s_add_u32 s56, s56, 65536
  s_add_u32 s57, s56, 4096
  s_add_u32 s62, s62, 0
  v_lshlrev_b32 v30, 4, v10
  v_lshl_add_u32 v29, v9, 11, v30
  v_lshl_add_u32 v29, v11, 3, v29
  s_lshl_b32 s58, s3, 7
  s_add_u32 s58, s58, 17024
  v_add_u32 v29, s58, v29
  v_lshl_add_u32 v31, v9, 8, v30
  v_lshl_add_u32 v31, v11, 11, v31
  v_lshl_add_u32 v30, v9, 7, v30
  s_lshl_b32 s58, s3, 11
  s_add_u32 s58, s58, 17024
  v_add_u32 v30, s58, v30
  v_lshlrev_b32 v33, 5, v10
  v_add_u32 v33, 25216, v33
  v_lshrrev_b32 v32, 5, v0
  v_lshl_add_u32 v32, v32, 4, v33
  s_lshl_b32 s58, s3, 2
  v_add_u32 v32, s58, v32
  s_lshr_b32 s58, s24, 1
  s_lshl_b32 s58, s58, 14
  s_add_u32 s58, s58, s62
  s_lshl_b32 s59, s3, 12
  s_add_u32 s58, s58, s59
  s_and_b32 s59, s24, 1
  s_lshl_b32 s59, s59, 7
  s_add_u32 s58, s58, s59
  v_lshrrev_b32 v34, 3, v1
  v_lshlrev_b32 v34, 26, v34
  v_lshl_add_u32 v34, v0, 3, v34
  s_lshl_b32 s59, s24, 7
  s_add_u32 s59, s59, s65
  v_mov_b32 v255, 0x3f803f80
  s_cmp_lg_u32 s3, 0
  s_cbranch_scc1 sequential_preLN__spectral_gfnet__dense_activation_squared_relu__prompt_kernel_skip3
  v_cmp_lt_u32 vcc, 1, v9
  v_mul_f32 v241, 0x3b000000, v248
  v_mul_f32 v240, 0x42000000, v249
  v_sub_f32 v246, 0x43f80000, v240
  v_mov_b32 v245, 0x42000000
  v_cndmask_b32 v240, v240, v246, vcc
  v_cndmask_b32 v245, v245, -v245, vcc
  v_mul_f32 v242, v240, v241
  v_add_f32 v240, v240, v245
  v_sin_f32 v243, v242
  v_cos_f32 v242, v242
  s_nop 0
  v_cvt_pk_bf16_f32 v244, v242, -v243
  v_cndmask_b32 v152, v244, 0, vcc
  v_cndmask_b32 v156, 0, v244, vcc
  v_mul_f32 v242, v240, v241
  v_add_f32 v240, v240, v245
  v_sin_f32 v243, v242
  v_cos_f32 v242, v242
  s_nop 0
  v_cvt_pk_bf16_f32 v244, v242, -v243
  v_cndmask_b32 v153, v244, 0, vcc
  v_cndmask_b32 v157, 0, v244, vcc
  v_mul_f32 v242, v240, v241
  v_add_f32 v240, v240, v245
  v_sin_f32 v243, v242
  v_cos_f32 v242, v242
  s_nop 0
  v_cvt_pk_bf16_f32 v244, v242, -v243
  v_cndmask_b32 v154, v244, 0, vcc
  v_cndmask_b32 v158, 0, v244, vcc
  v_mul_f32 v242, v240, v241
  v_add_f32 v240, v240, v245
  v_sin_f32 v243, v242
  v_cos_f32 v242, v242
  s_nop 0
  v_cvt_pk_bf16_f32 v244, v242, -v243
  v_cndmask_b32 v155, v244, 0, vcc
  v_cndmask_b32 v159, 0, v244, vcc
  v_and_b32 v242, 1, v8
  v_lshlrev_b32 v242, 31, v242
  v_or_b32 v242, 0x3f003f00, v242
  v_cmp_eq_u32 vcc, 0, v9
  s_nop 1
  v_cndmask_b32 v152, v152, v242, vcc
sequential_preLN__spectral_gfnet__dense_activation_squared_relu__prompt_kernel_skip3:
  v_cmp_eq_u32 vcc, 0, v0
  v_mov_b32 v3, 2146435072
  v_mov_b32 v4, s71
  v_cndmask_b32 v3, v3, 0, vcc
  s_lshl_b32 s12, s24, 4
  s_lshl_b32 s13, s3, 2
  s_add_u32 s12, s12, s13
  s_add_u32 s12, s12, s65
  v_and_b32 v5, 31, v0
  v_lshlrev_b32 v5, 2, v5
  s_lshr_b32 s17, s3, 1
  s_mul_i32 s17, s17, 3
  s_mul_i32 s15, s24, 6
  s_add_u32 s17, s17, s15
  s_and_b32 s15, s3, 1
  s_lshl_b32 s16, s15, 1
  s_add_u32 s16, s16, s17
  s_add_u32 s17, s17, 1
  v_lshlrev_b32 v1, 3, v9
  s_lshl_b32 s13, s16, 6
  s_lshl_b32 s14, s17, 6
  s_lshl_b32 s18, s15, 5
  s_add_u32 s14, s14, s18
  buffer_load_dwordx2 v[80:81], v1, s[36:39], s13 offen
  buffer_load_dwordx2 v[82:83], v1, s[36:39], s13 offen offset:32
  buffer_load_dwordx2 v[84:85], v1, s[36:39], s14 offen
  v_lshlrev_b32 v2, 3, v8
  s_lshl_b32 s19, s24, 7
  buffer_load_dwordx2 v[86:87], v2, s[40:43], s19 offen
  s_add_u32 s18, s62, 65536
  s_cmp_ge_u32 s16, 43
  s_cselect_b32 s13, 2146435072, s18
  s_lshl_b32 s16, s16, 10
  s_add_u32 s16, s16, s13
  s_cmp_ge_u32 s17, 43
  s_cselect_b32 s13, 2146435072, s18
  s_lshl_b32 s17, s17, 10
  s_add_u32 s17, s17, s13
  s_lshl_b32 s15, s15, 3
  s_add_u32 s17, s17, s15
  s_mul_i32 s14, s3, 11
  s_lshl_b32 s15, s14, 10
  s_add_u32 s18, s18, s15
  s_cmp_eq_u32 s3, 3
  s_cselect_b32 s13, 2146435072, s18
  s_lshl_b32 s60, s14, 15
  s_add_u32 s60, s60, s19
  s_mul_i32 s61, s3, 12288
  s_add_u32 s61, s61, 107392
  v_add_u32 v13, 4096, v12
  v_add_u32 v14, 8192, v12
  s_lshl_b32 s14, s24, 4
  s_sub_u32 s14, s73, s14
  s_and_b32 s15, s3, 1
  s_lshl_b32 s64, s15, 5
  s_lshl_b32 s15, s15, 3
  s_add_u32 s14, s14, s15
  s_lshr_b32 s15, s3, 1
  s_lshl_b32 s20, s15, 7
  s_add_u32 s64, s64, s20
  s_waitcnt vmcnt(4)
  s_barrier
  s_add_u32 s64, s64, s65
  v_bfe_u32 v36, v0, 2, 2
  s_lshl_b32 s15, s15, 4
  v_lshl_add_u32 v36, v9, 3, v36
  s_add_u32 s14, s14, s15
  v_mul_u32_u24 v36, 416, v36
  s_lshl_b32 s14, s14, 10
  v_and_b32 v37, 3, v0
  s_add_u32 s19, s19, s14
  v_lshl_add_u32 v36, v37, 3, v36
  v_lshl_add_u32 v2, v9, 17, v2
  s_lshr_b32 s68, s3, 1
  v_and_b32 v76, 3, v0
  s_mul_i32 s68, s68, 192
  v_bfe_u32 v77, v0, 2, 2
  s_and_b32 s69, s3, 1
  v_lshlrev_b32 v15, 12, v76
  s_lshl_b32 s69, s69, 5
  v_lshl_add_u32 v15, v77, 2, v15
  s_add_u32 s68, s68, 41856
  v_lshl_add_u32 v15, v9, 4, v15
  s_add_u32 s69, s69, s68
  s_lshr_b32 s14, s24, 2
  s_add_u32 s69, s69, 64
  s_lshl_b32 s14, s14, 10
  v_add_u32 v37, s69, v36
  s_and_b32 s15, s24, 3
  s_and_b32 s69, s3, 1
  s_lshl_b32 s15, s15, 8
  s_lshl_b32 s69, s69, 7
  s_add_u32 s14, s14, s15
  s_add_u32 s69, s69, s68
  s_lshl_b32 s15, s3, 6
  v_add_u32 v36, s69, v36
  s_add_u32 s14, s14, s15
  v_add_u32 v38, 54016, v36
  s_add_u32 s14, s14, 41856
  v_add_u32 v39, 54016, v37
  v_add_u32 v15, s14, v15
  ds_read_b64_tr_b16 a[32:33], v36 offset:0
  v_mul_u32_u24 v11, 1312, v77
  ds_read_b64_tr_b16 a[34:35], v36 offset:1664
  v_mul_u32_u24 v72, 320, v76
  ds_read_b64_tr_b16 a[96:97], v36 offset:32
  v_add_u32 v11, v11, v72
  ds_read_b64_tr_b16 a[98:99], v36 offset:1696
  v_lshl_add_u32 v11, v9, 4, v11
  ds_read_b64_tr_b16 a[160:161], v37 offset:0
  v_add_u32 v11, s15, v11
  ds_read_b64_tr_b16 a[162:163], v37 offset:1664
  v_mul_u32_u24 v10, 320, v9
  ds_read_b64_tr_b16 a[36:37], v36 offset:13504
  v_lshl_add_u32 v10, v8, 4, v10
  ds_read_b64_tr_b16 a[38:39], v36 offset:15168
  s_mul_i32 s14, s3, 5248
  ds_read_b64_tr_b16 a[100:101], v36 offset:13536
  v_add_u32 v10, s14, v10
  ds_read_b64_tr_b16 a[102:103], v36 offset:15200
  v_add_u32 v78, 107392, v10
  ds_read_b64_tr_b16 a[164:165], v37 offset:13504
  v_add_u32 v79, 107392, v11
  ds_read_b64_tr_b16 a[166:167], v37 offset:15168
  v_lshrrev_b32 v72, 3, v0
  ds_read_b64_tr_b16 a[40:41], v36 offset:27008
  v_lshrrev_b32 v68, 2, v72
  ds_read_b64_tr_b16 a[42:43], v36 offset:28672
  v_and_b32 v69, 3, v72
  s_waitcnt lgkmcnt(12)
  ds_read_b64_tr_b16 a[104:105], v36 offset:27040
  v_lshl_add_u32 v68, v68, 4, v69
  ds_read_b64_tr_b16 a[106:107], v36 offset:28704
  v_lshlrev_b32 v68, 10, v68
  s_waitcnt lgkmcnt(12)
  ds_read_b64_tr_b16 a[168:169], v37 offset:27008
  v_bfe_u32 v72, v72, 1, 1
  ds_read_b64_tr_b16 a[170:171], v37 offset:28672
  v_lshlrev_b32 v72, 5, v72
  s_waitcnt lgkmcnt(12)
  ds_read_b64_tr_b16 a[44:45], v36 offset:40512
  v_and_b32 v69, 7, v0
  ds_read_b64_tr_b16 a[46:47], v36 offset:42176
  v_lshlrev_b32 v69, 4, v69
  s_waitcnt lgkmcnt(12)
  ds_read_b64_tr_b16 a[108:109], v36 offset:40544
  v_xor_b32 v69, v69, v72
  ds_read_b64_tr_b16 a[110:111], v36 offset:42208
  v_add_u32 v68, v68, v69
  s_waitcnt lgkmcnt(12)
  ds_read_b64_tr_b16 a[172:173], v37 offset:40512
  v_xor_b32 v69, 64, v68
  ds_read_b64_tr_b16 a[174:175], v37 offset:42176
  v_add_u32 v69, 3072, v69
  s_waitcnt lgkmcnt(12)
  ds_read_b64_tr_b16 a[48:49], v38 offset:0
  v_add_u32 v70, 6144, v68
  ds_read_b64_tr_b16 a[50:51], v38 offset:1664
  v_add_u32 v71, 6144, v69
  s_waitcnt lgkmcnt(12)
  ds_read_b64_tr_b16 a[112:113], v38 offset:32
  v_lshl_add_u32 v72, v9, 3, v77
  ds_read_b64_tr_b16 a[114:115], v38 offset:1696
  v_lshlrev_b32 v72, 7, v72
  s_waitcnt lgkmcnt(12)
  ds_read_b64_tr_b16 a[176:177], v39 offset:0
  v_lshrrev_b32 v77, 1, v77
  ds_read_b64_tr_b16 a[178:179], v39 offset:1664
  v_lshl_add_u32 v72, v77, 5, v72
  s_waitcnt lgkmcnt(12)
  ds_read_b64_tr_b16 a[52:53], v38 offset:13504
  v_and_b32 v77, 1, v9
  ds_read_b64_tr_b16 a[54:55], v38 offset:15168
  v_lshl_add_u32 v72, v77, 6, v72
  s_waitcnt lgkmcnt(12)
  ds_read_b64_tr_b16 a[116:117], v38 offset:13536
  v_lshl_add_u32 v72, v76, 3, v72
  ds_read_b64_tr_b16 a[118:119], v38 offset:15200
  v_xor_b32 v73, 32, v72
  s_waitcnt lgkmcnt(12)
  ds_read_b64_tr_b16 a[180:181], v39 offset:13504
  v_xor_b32 v74, 64, v72
  ds_read_b64_tr_b16 a[182:183], v39 offset:15168
  v_xor_b32 v75, 96, v72
  s_waitcnt lgkmcnt(12)
  ds_read_b64_tr_b16 a[56:57], v38 offset:27008
  v_add_u32 v72, s61, v72
  ds_read_b64_tr_b16 a[58:59], v38 offset:28672
  v_add_u32 v73, s61, v73
  s_waitcnt lgkmcnt(12)
  ds_read_b64_tr_b16 a[120:121], v38 offset:27040
  v_add_u32 v74, s61, v74
  ds_read_b64_tr_b16 a[122:123], v38 offset:28704
  v_add_u32 v75, s61, v75
  s_waitcnt lgkmcnt(12)
  ds_read_b64_tr_b16 a[184:185], v39 offset:27008
  s_lshl_b32 s15, s3, 12
  ds_read_b64_tr_b16 a[186:187], v39 offset:28672
  s_add_u32 s14, s15, s62
  s_waitcnt lgkmcnt(12)
  ds_read_b64_tr_b16 a[60:61], v38 offset:40512
  s_add_u32 s15, s15, 41856
  ds_read_b64_tr_b16 a[62:63], v38 offset:42176
  s_waitcnt vmcnt(3)
  v_lshlrev_b32 v16, 16, v80
  s_waitcnt lgkmcnt(12)
  ds_read_b64_tr_b16 a[124:125], v38 offset:40544
  v_and_b32 v17, 0xffff0000, v80
  ds_read_b64_tr_b16 a[126:127], v38 offset:42208
  v_lshlrev_b32 v18, 16, v81
  s_waitcnt lgkmcnt(12)
  ds_read_b64_tr_b16 a[188:189], v39 offset:40512
  v_and_b32 v19, 0xffff0000, v81
  ds_read_b64_tr_b16 a[190:191], v39 offset:42176
  s_waitcnt vmcnt(2)
  v_lshlrev_b32 v20, 16, v82
  v_and_b32 v21, 0xffff0000, v82
  v_lshlrev_b32 v22, 16, v83
  v_and_b32 v23, 0xffff0000, v83
  s_waitcnt vmcnt(1)
  v_lshlrev_b32 v24, 16, v84
  v_and_b32 v25, 0xffff0000, v84
  v_lshlrev_b32 v26, 16, v85
  v_and_b32 v27, 0xffff0000, v85
  v_add_u32 v7, 41856, v12
  s_waitcnt lgkmcnt(0)
  s_barrier
  buffer_load_dword v216, v28, s[28:31], s56 offen offset:0 sc1
  buffer_load_dword v217, v28, s[28:31], s56 offen offset:256 sc1
  buffer_load_dword v218, v28, s[28:31], s56 offen offset:512 sc1
  buffer_load_dword v219, v28, s[28:31], s56 offen offset:768 sc1
  buffer_load_dword v220, v28, s[28:31], s57 offen offset:0 sc1
  buffer_load_dword v221, v28, s[28:31], s57 offen offset:256 sc1
  buffer_load_dword v222, v28, s[28:31], s57 offen offset:512 sc1
  buffer_load_dword v223, v28, s[28:31], s57 offen offset:768 sc1
  s_add_u32 m0, s61, 0
  s_nop 0
  buffer_load_dwordx4 v68, s[48:51], s60 offen offset:0 lds
  buffer_load_dwordx4 v69, s[48:51], s60 offen offset:1024 lds
  buffer_load_dwordx4 v70, s[48:51], s60 offen offset:2048 lds
  buffer_load_dwordx4 v71, s[48:51], s60 offen offset:3072 lds
  s_add_u32 s60, s60, 32768
  s_add_u32 m0, s61, 4096
  s_nop 0
  buffer_load_dwordx4 v68, s[48:51], s60 offen offset:0 lds
  buffer_load_dwordx4 v69, s[48:51], s60 offen offset:1024 lds
  buffer_load_dwordx4 v70, s[48:51], s60 offen offset:2048 lds
  buffer_load_dwordx4 v71, s[48:51], s60 offen offset:3072 lds
  s_add_u32 s60, s60, 32768
  s_add_u32 m0, s61, 8192
  s_nop 0
  buffer_load_dwordx4 v68, s[48:51], s60 offen offset:0 lds
  buffer_load_dwordx4 v69, s[48:51], s60 offen offset:1024 lds
  buffer_load_dwordx4 v70, s[48:51], s60 offen offset:2048 lds
  buffer_load_dwordx4 v71, s[48:51], s60 offen offset:3072 lds
  s_add_u32 s60, s60, 32768
  s_lshr_b32 s66, s26, 3
  s_mul_i32 s66, s66, 360448
  s_and_b32 s20, s26, 7
  s_lshl_b32 s20, s20, 2
  s_add_u32 s20, s20, s3
  s_mul_i32 s20, s20, 6144
  s_add_u32 s66, s66, s20
  v_min_u32 v6, 47, v0
  v_lshlrev_b32 v6, 7, v6
  buffer_load_dword v40, v6, s[48:51], s66 offen
  s_waitcnt vmcnt(18)
  v_max3_u32 v240, v216, v217, v218
  s_waitcnt vmcnt(15)
  v_max3_u32 v241, v219, v220, v221
  s_waitcnt vmcnt(13)
  v_max3_u32 v240, v240, v222, v223
  v_max_u32 v240, v240, v241
  v_cmp_eq_u32 vcc, -1, v240
  s_nop 1
  s_cbranch_vccnz pz2_retry
pz2_ok:
  v_mfma_f32_16x16x32_bf16 v[224:227], v[144:147], v[216:219], 0
  v_mfma_f32_16x16x32_bf16 v[228:231], v[148:151], v[216:219], 0
  v_mfma_f32_16x16x32_bf16 v[232:235], v[144:147], v[220:223], 0
  v_mfma_f32_16x16x32_bf16 v[236:239], v[148:151], v[220:223], 0
  s_cmp_lg_u32 s3, 0
  s_cbranch_scc1 sequential_preLN__spectral_gfnet__dense_activation_squared_relu__prompt_kernel_skip4
  v_mfma_f32_16x16x32_bf16 v[240:243], v[152:155], v[216:219], 0
  v_mfma_f32_16x16x32_bf16 v[244:247], v[156:159], v[216:219], 0
  s_nop 6
  v_cndmask_b32 v224, v224, v240, s[4:5]
  v_cndmask_b32 v225, v225, v241, s[4:5]
  v_cndmask_b32 v226, v226, v242, s[4:5]
  v_cndmask_b32 v227, v227, v243, s[4:5]
  v_cndmask_b32 v228, v228, v244, s[4:5]
  v_cndmask_b32 v229, v229, v245, s[4:5]
  v_cndmask_b32 v230, v230, v246, s[4:5]
  v_cndmask_b32 v231, v231, v247, s[4:5]
sequential_preLN__spectral_gfnet__dense_activation_squared_relu__prompt_kernel_skip4:
  s_nop 7
  v_cvt_pk_bf16_f32 v240, v224, v228
  v_cvt_pk_bf16_f32 v241, v232, v236
  ds_write_b64 v29, v[240:241] offset:0
  v_cvt_pk_bf16_f32 v242, v225, v229
  v_cvt_pk_bf16_f32 v243, v233, v237
  ds_write_b64 v29, v[242:243] offset:512
  v_cvt_pk_bf16_f32 v244, v226, v230
  v_cvt_pk_bf16_f32 v245, v234, v238
  ds_write_b64 v29, v[244:245] offset:1024
  v_cvt_pk_bf16_f32 v246, v227, v231
  v_cvt_pk_bf16_f32 v247, v235, v239
  ds_write_b64 v29, v[246:247] offset:1536
  s_waitcnt lgkmcnt(0)
  s_barrier
  s_mov_b64 exec, s[4:5]
  ds_read_b128 v[128:131], v30
  ds_read_b128 v[132:135], v30 offset:512
  s_mov_b64 exec, s[6:7]
  ds_read_b128 v[136:139], v30 offset:1024
  ds_read_b128 v[140:143], v30 offset:1536
  s_mov_b64 exec, -1
  s_waitcnt lgkmcnt(3)
  v_mfma_f32_16x16x32_bf16 v[192:195], v[160:163], v[128:131], v[192:195]
  v_mfma_f32_16x16x32_bf16 v[196:199], v[164:167], v[128:131], v[196:199]
  s_waitcnt lgkmcnt(2)
  v_mfma_f32_16x16x32_bf16 v[200:203], v[168:171], v[132:135], v[200:203]
  v_mfma_f32_16x16x32_bf16 v[204:207], v[172:175], v[132:135], v[204:207]
  s_waitcnt lgkmcnt(1)
  v_mfma_f32_16x16x32_bf16 v[192:195], v[176:179], v[136:139], v[192:195]
  v_mfma_f32_16x16x32_bf16 v[196:199], v[180:183], v[136:139], v[196:199]
  s_waitcnt lgkmcnt(0)
  v_mfma_f32_16x16x32_bf16 v[200:203], v[184:187], v[140:143], v[200:203]
  v_mfma_f32_16x16x32_bf16 v[204:207], v[188:191], v[140:143], v[204:207]
  v_mov_b32 v248, 0
  v_mov_b32 v249, 0
  v_mov_b32 v250, 0
  v_mov_b32 v251, 0
  s_nop 2
  v_cvt_pk_bf16_f32 v240, v192, v200
  v_cvt_pk_bf16_f32 v241, v193, v201
  v_cvt_pk_bf16_f32 v242, v194, v202
  v_cvt_pk_bf16_f32 v243, v195, v203
  v_cvt_pk_bf16_f32 v244, v196, v204
  v_cvt_pk_bf16_f32 v245, v197, v205
  v_cvt_pk_bf16_f32 v246, v198, v206
  v_cvt_pk_bf16_f32 v247, v199, v207
  v_dot2c_f32_bf16 v248, v240, v255
  v_dot2c_f32_bf16 v249, v240, v240
  v_dot2c_f32_bf16 v250, v244, v255
  v_dot2c_f32_bf16 v251, v244, v244
  v_dot2c_f32_bf16 v248, v241, v255
  v_dot2c_f32_bf16 v249, v241, v241
  v_dot2c_f32_bf16 v250, v245, v255
  v_dot2c_f32_bf16 v251, v245, v245
  v_dot2c_f32_bf16 v248, v242, v255
  v_dot2c_f32_bf16 v249, v242, v242
  v_dot2c_f32_bf16 v250, v246, v255
  v_dot2c_f32_bf16 v251, v246, v246
  v_dot2c_f32_bf16 v248, v243, v255
  v_dot2c_f32_bf16 v249, v243, v243
  v_dot2c_f32_bf16 v250, v247, v255
  v_dot2c_f32_bf16 v251, v247, v247
  s_nop 1
  v_add_f32 v248, v248, v250
  v_add_f32 v249, v249, v251
  s_nop 1
  v_permlane32_swap_b32 v248, v249
  v_add_f32 v248, v248, v249
  v_mov_b32 v249, v248
  s_nop 1
  v_permlane16_swap_b32 v248, v249
  v_add_f32 v248, v248, v249
  s_nop 1
  v_add_f32_dpp v248, v248, v248 row_ror:8 row_mask:0xf bank_mask:0xf
  ds_write_b32 v32, v248
  s_waitcnt lgkmcnt(0)
  s_barrier
  ds_read_b128 v[224:227], v33
  ds_read_b128 v[228:231], v33 offset:16
  s_waitcnt lgkmcnt(1)
  v_add_f32 v224, v224, v225
  v_add_f32 v226, v226, v227
  s_waitcnt lgkmcnt(0)
  v_add_f32 v228, v228, v229
  v_add_f32 v230, v230, v231
  v_add_f32 v224, v224, v226
  v_add_f32 v228, v228, v230
  v_mul_f32 v224, 0x3b000000, v224
  v_mul_f32 v228, 0x3b000000, v228
  v_fma_f32 v228, -v224, v224, v228
  v_max_f32 v228, 0, v228
  v_add_f32 v225, 0x3727c5ac, v228
  v_rsq_f32 v228, v225
  s_nop 0
  v_mul_f32 v229, -v224, v228
  v_pk_fma_f32 v[192:193], v[192:193], v[228:229], v[228:229] op_sel:[0,0,1] op_sel_hi:[1,0,1]
  v_pk_fma_f32 v[194:195], v[194:195], v[228:229], v[228:229] op_sel:[0,0,1] op_sel_hi:[1,0,1]
  v_pk_fma_f32 v[196:197], v[196:197], v[228:229], v[228:229] op_sel:[0,0,1] op_sel_hi:[1,0,1]
  v_pk_fma_f32 v[198:199], v[198:199], v[228:229], v[228:229] op_sel:[0,0,1] op_sel_hi:[1,0,1]
  v_pk_fma_f32 v[200:201], v[200:201], v[228:229], v[228:229] op_sel:[0,0,1] op_sel_hi:[1,0,1]
  v_pk_fma_f32 v[202:203], v[202:203], v[228:229], v[228:229] op_sel:[0,0,1] op_sel_hi:[1,0,1]
  v_pk_fma_f32 v[204:205], v[204:205], v[228:229], v[228:229] op_sel:[0,0,1] op_sel_hi:[1,0,1]
  v_pk_fma_f32 v[206:207], v[206:207], v[228:229], v[228:229] op_sel:[0,0,1] op_sel_hi:[1,0,1]
  v_cvt_pk_bf16_f32 v216, v192, v200
  v_cvt_pk_bf16_f32 v217, v193, v201
  v_cvt_pk_bf16_f32 v218, v194, v202
  v_cvt_pk_bf16_f32 v219, v195, v203
  v_cvt_pk_bf16_f32 v220, v196, v204
  v_cvt_pk_bf16_f32 v221, v197, v205
  v_cvt_pk_bf16_f32 v222, v198, v206
  v_cvt_pk_bf16_f32 v223, v199, v207
  v_mul_f32 v225, v225, v228
  buffer_store_dwordx4 v[216:219], v31, s[28:31], s58 offen offset:0
  buffer_store_dwordx4 v[220:223], v31, s[28:31], s58 offen offset:1024
  buffer_store_dwordx2 v[224:225], v34, s[28:31], s59 offen offset:2048
  s_waitcnt vmcnt(12)
  ds_read_b64_tr_b16 a[192:193], v72 offset:0
  ds_read_b64_tr_b16 a[194:195], v72 offset:512
  ds_read_b64_tr_b16 a[196:197], v73 offset:0
  ds_read_b64_tr_b16 a[198:199], v73 offset:512
  ds_read_b64_tr_b16 a[200:201], v74 offset:0
  ds_read_b64_tr_b16 a[202:203], v74 offset:512
  ds_read_b64_tr_b16 a[204:205], v75 offset:0
  ds_read_b64_tr_b16 a[206:207], v75 offset:512
  s_waitcnt vmcnt(8)
  ds_read_b64_tr_b16 a[208:209], v72 offset:4096
  ds_read_b64_tr_b16 a[210:211], v72 offset:4608
  ds_read_b64_tr_b16 a[212:213], v73 offset:4096
  ds_read_b64_tr_b16 a[214:215], v73 offset:4608
  ds_read_b64_tr_b16 a[216:217], v74 offset:4096
  ds_read_b64_tr_b16 a[218:219], v74 offset:4608
  s_waitcnt lgkmcnt(12)
  ds_read_b64_tr_b16 a[220:221], v75 offset:4096
  ds_read_b64_tr_b16 a[222:223], v75 offset:4608
  s_waitcnt vmcnt(4)
  s_waitcnt lgkmcnt(12)
  ds_read_b64_tr_b16 a[224:225], v72 offset:8192
  ds_read_b64_tr_b16 a[226:227], v72 offset:8704
  s_waitcnt lgkmcnt(12)
  ds_read_b64_tr_b16 a[228:229], v73 offset:8192
  ds_read_b64_tr_b16 a[230:231], v73 offset:8704
  s_waitcnt lgkmcnt(12)
  ds_read_b64_tr_b16 a[232:233], v74 offset:8192
  ds_read_b64_tr_b16 a[234:235], v74 offset:8704
  s_waitcnt lgkmcnt(12)
  ds_read_b64_tr_b16 a[236:237], v75 offset:8192
  ds_read_b64_tr_b16 a[238:239], v75 offset:8704
  s_waitcnt vmcnt(0)
  buffer_store_dword v4, v3, s[28:31], s12 offen offset:128
  v_lshlrev_b32 v132, 16, v86
  v_and_b32 v133, 0xffff0000, v86
  v_lshlrev_b32 v134, 16, v87
  v_and_b32 v135, 0xffff0000, v87
  v_add_u32 v86, 32768, v15
  buffer_load_dword v6, v5, s[28:31], s65 offen offset:128 sc1
  s_waitcnt vmcnt(0)
  v_cmp_ne_u32 vcc, s71, v6
  s_nop 1
  s_cbranch_vccnz pf3_retry
pf3_ok:
  s_mov_b32 m0, s15
  s_nop 0
  buffer_load_dwordx4 v12, s[28:31], s14 offen offset:0 sc1 lds
  buffer_load_dwordx4 v12, s[28:31], s14 offen offset:1024 sc1 lds
  buffer_load_dwordx4 v12, s[28:31], s14 offen offset:2048 sc1 lds
  buffer_load_dwordx4 v12, s[28:31], s14 offen offset:3072 sc1 lds
  s_add_u32 s14, s14, 16384
  s_add_u32 s15, s15, 16384
  s_mov_b32 m0, s15
  s_nop 0
  buffer_load_dwordx4 v12, s[28:31], s14 offen offset:0 sc1 lds
  buffer_load_dwordx4 v12, s[28:31], s14 offen offset:1024 sc1 lds
  buffer_load_dwordx4 v12, s[28:31], s14 offen offset:2048 sc1 lds
  buffer_load_dwordx4 v12, s[28:31], s14 offen offset:3072 sc1 lds
  s_add_u32 s14, s14, 16384
  s_add_u32 s15, s15, 16384
  buffer_load_dwordx2 v[136:137], v1, s[28:31], s64 offen offset:2048 sc1
  buffer_load_dwordx2 v[138:139], v1, s[28:31], s64 offen offset:2304 sc1
  buffer_load_dwordx2 v[140:141], v1, s[28:31], s64 offen offset:2560 sc1
  buffer_load_dwordx2 v[142:143], v1, s[28:31], s64 offen offset:2816 sc1
  s_add_u32 m0, s61, 0
  s_nop 0
  buffer_load_dwordx4 v68, s[48:51], s60 offen offset:0 lds
  buffer_load_dwordx4 v69, s[48:51], s60 offen offset:1024 lds
  buffer_load_dwordx4 v70, s[48:51], s60 offen offset:2048 lds
  buffer_load_dwordx4 v71, s[48:51], s60 offen offset:3072 lds
  s_add_u32 s60, s60, 32768
  s_waitcnt lgkmcnt(8)
  s_add_u32 m0, s61, 4096
  s_nop 0
  buffer_load_dwordx4 v68, s[48:51], s60 offen offset:0 lds
  buffer_load_dwordx4 v69, s[48:51], s60 offen offset:1024 lds
  buffer_load_dwordx4 v70, s[48:51], s60 offen offset:2048 lds
  buffer_load_dwordx4 v71, s[48:51], s60 offen offset:3072 lds
  s_add_u32 s60, s60, 32768
  s_waitcnt lgkmcnt(0)
  s_add_u32 m0, s61, 8192
  s_nop 0
  buffer_load_dwordx4 v68, s[48:51], s60 offen offset:0 lds
  buffer_load_dwordx4 v69, s[48:51], s60 offen offset:1024 lds
  buffer_load_dwordx4 v70, s[48:51], s60 offen offset:2048 lds
  buffer_load_dwordx4 v71, s[48:51], s60 offen offset:3072 lds
  s_add_u32 s60, s60, 32768
  s_waitcnt vmcnt(20)
  s_barrier
  ds_read_b128 v[28:31], v7 offset:0
  ds_read_b128 v[32:35], v7 offset:1024
  ds_read_b128 v[36:39], v7 offset:2048
  s_waitcnt lgkmcnt(2)
  v_mfma_f32_16x16x32_bf16 v[44:47], a[0:3], v[28:31], v[16:19]
  s_mov_b32 m0, s15
  s_nop 0
  buffer_load_dwordx4 v12, s[28:31], s14 offen offset:0 sc1 lds
  v_mfma_f32_16x16x32_bf16 v[48:51], a[64:67], v[28:31], v[20:23]
  v_mfma_f32_16x16x32_bf16 v[52:55], a[128:131], v[28:31], v[24:27]
  ds_read_b128 v[40:43], v7 offset:3072
  s_waitcnt lgkmcnt(2)
  v_mfma_f32_16x16x32_bf16 v[44:47], a[4:7], v[32:35], v[44:47]
  buffer_load_dwordx4 v12, s[28:31], s14 offen offset:1024 sc1 lds
  v_mfma_f32_16x16x32_bf16 v[48:51], a[68:71], v[32:35], v[48:51]
  v_mfma_f32_16x16x32_bf16 v[52:55], a[132:135], v[32:35], v[52:55]
  ds_read_b128 v[28:31], v7 offset:4096
  s_waitcnt lgkmcnt(2)
  v_mfma_f32_16x16x32_bf16 v[44:47], a[8:11], v[36:39], v[44:47]
  buffer_load_dwordx4 v12, s[28:31], s14 offen offset:2048 sc1 lds
  v_mfma_f32_16x16x32_bf16 v[48:51], a[72:75], v[36:39], v[48:51]
  v_mfma_f32_16x16x32_bf16 v[52:55], a[136:139], v[36:39], v[52:55]
  ds_read_b128 v[32:35], v7 offset:5120
  s_waitcnt lgkmcnt(2)
  v_mfma_f32_16x16x32_bf16 v[44:47], a[12:15], v[40:43], v[44:47]
  buffer_load_dwordx4 v12, s[28:31], s14 offen offset:3072 sc1 lds
  v_mfma_f32_16x16x32_bf16 v[48:51], a[76:79], v[40:43], v[48:51]
  s_add_u32 s14, s14, 16384
  s_add_u32 s15, s15, 16384
  v_mfma_f32_16x16x32_bf16 v[52:55], a[140:143], v[40:43], v[52:55]
  s_mov_b32 m0, s15
  ds_read_b128 v[36:39], v7 offset:6144
  s_waitcnt lgkmcnt(2)
  v_mfma_f32_16x16x32_bf16 v[44:47], a[16:19], v[28:31], v[44:47]
  buffer_load_dwordx4 v12, s[28:31], s14 offen offset:0 sc1 lds
  v_mfma_f32_16x16x32_bf16 v[48:51], a[80:83], v[28:31], v[48:51]
  v_mfma_f32_16x16x32_bf16 v[52:55], a[144:147], v[28:31], v[52:55]
  ds_read_b128 v[40:43], v7 offset:7168
  s_waitcnt lgkmcnt(2)
  v_mfma_f32_16x16x32_bf16 v[44:47], a[20:23], v[32:35], v[44:47]
  buffer_load_dwordx4 v12, s[28:31], s14 offen offset:1024 sc1 lds
  v_mfma_f32_16x16x32_bf16 v[48:51], a[84:87], v[32:35], v[48:51]
  v_mfma_f32_16x16x32_bf16 v[52:55], a[148:151], v[32:35], v[52:55]
  ds_read_b128 v[28:31], v7 offset:8192
  s_waitcnt lgkmcnt(2)
  v_mfma_f32_16x16x32_bf16 v[44:47], a[24:27], v[36:39], v[44:47]
  buffer_load_dwordx4 v12, s[28:31], s14 offen offset:2048 sc1 lds
  v_mfma_f32_16x16x32_bf16 v[48:51], a[88:91], v[36:39], v[48:51]
  v_mfma_f32_16x16x32_bf16 v[52:55], a[152:155], v[36:39], v[52:55]
  ds_read_b128 v[32:35], v7 offset:9216
  s_waitcnt lgkmcnt(2)
  v_mfma_f32_16x16x32_bf16 v[44:47], a[28:31], v[40:43], v[44:47]
  buffer_load_dwordx4 v12, s[28:31], s14 offen offset:3072 sc1 lds
  v_mfma_f32_16x16x32_bf16 v[48:51], a[92:95], v[40:43], v[48:51]
  s_waitcnt vmcnt(16)
  ds_read_b64_tr_b16 a[240:241], v72 offset:0
  ds_read_b64_tr_b16 a[242:243], v72 offset:512
  v_mfma_f32_16x16x32_bf16 v[52:55], a[156:159], v[40:43], v[52:55]
  ds_read_b64_tr_b16 a[244:245], v73 offset:0
  ds_read_b128 v[36:39], v7 offset:10240
  s_waitcnt lgkmcnt(5)
  v_mfma_f32_16x16x32_bf16 v[44:47], a[32:35], v[28:31], v[44:47]
  ds_read_b64_tr_b16 a[246:247], v73 offset:512
  ds_read_b64_tr_b16 a[248:249], v74 offset:0
  v_mfma_f32_16x16x32_bf16 v[48:51], a[96:99], v[28:31], v[48:51]
  ds_read_b64_tr_b16 a[250:251], v74 offset:512
  ds_read_b64_tr_b16 a[252:253], v75 offset:0
  v_mfma_f32_16x16x32_bf16 v[52:55], a[160:163], v[28:31], v[52:55]
  ds_read_b64_tr_b16 a[254:255], v75 offset:512
  ds_read_b128 v[40:43], v7 offset:11264
  s_waitcnt lgkmcnt(10)
  v_mfma_f32_16x16x32_bf16 v[44:47], a[36:39], v[32:35], v[44:47]
  v_mfma_f32_16x16x32_bf16 v[48:51], a[100:103], v[32:35], v[48:51]
  v_mfma_f32_16x16x32_bf16 v[52:55], a[164:167], v[32:35], v[52:55]
  s_waitcnt lgkmcnt(1)
  s_add_u32 m0, s61, 0
  ds_read_b128 v[28:31], v7 offset:12288
  v_mfma_f32_16x16x32_bf16 v[44:47], a[40:43], v[36:39], v[44:47]
  buffer_load_dwordx4 v68, s[48:51], s60 offen offset:0 lds
  v_mfma_f32_16x16x32_bf16 v[48:51], a[104:107], v[36:39], v[48:51]
  v_mfma_f32_16x16x32_bf16 v[52:55], a[168:171], v[36:39], v[52:55]
  ds_read_b128 v[32:35], v7 offset:13312
  s_waitcnt lgkmcnt(2)
  v_mfma_f32_16x16x32_bf16 v[44:47], a[44:47], v[40:43], v[44:47]
  buffer_load_dwordx4 v69, s[48:51], s60 offen offset:1024 lds
  v_mfma_f32_16x16x32_bf16 v[48:51], a[108:111], v[40:43], v[48:51]
  v_mfma_f32_16x16x32_bf16 v[52:55], a[172:175], v[40:43], v[52:55]
  ds_read_b128 v[36:39], v7 offset:14336
  s_barrier
  s_waitcnt lgkmcnt(2)
  v_mfma_f32_16x16x32_bf16 v[44:47], a[48:51], v[28:31], v[44:47]
  buffer_load_dwordx4 v70, s[48:51], s60 offen offset:2048 lds
  v_mfma_f32_16x16x32_bf16 v[48:51], a[112:115], v[28:31], v[48:51]
  v_mfma_f32_16x16x32_bf16 v[52:55], a[176:179], v[28:31], v[52:55]
  ds_read_b128 v[40:43], v7 offset:15360
  s_waitcnt lgkmcnt(2)
  v_mfma_f32_16x16x32_bf16 v[44:47], a[52:55], v[32:35], v[44:47]
  buffer_load_dwordx4 v71, s[48:51], s60 offen offset:3072 lds
  v_mfma_f32_16x16x32_bf16 v[48:51], a[116:119], v[32:35], v[48:51]
  s_add_u32 s60, s60, 32768
  s_waitcnt vmcnt(16)
  ds_read_b64_tr_b16 v[144:145], v72 offset:4096
  v_mfma_f32_16x16x32_bf16 v[52:55], a[180:183], v[32:35], v[52:55]
  ds_read_b64_tr_b16 v[146:147], v72 offset:4608
  ds_read_b128 v[28:31], v7 offset:16384
  s_waitcnt lgkmcnt(4)
  v_mfma_f32_16x16x32_bf16 v[44:47], a[56:59], v[36:39], v[44:47]
  ds_read_b64_tr_b16 v[148:149], v73 offset:4096
  ds_read_b64_tr_b16 v[150:151], v73 offset:4608
  v_mfma_f32_16x16x32_bf16 v[48:51], a[120:123], v[36:39], v[48:51]
  ds_read_b64_tr_b16 v[152:153], v74 offset:4096
  ds_read_b64_tr_b16 v[154:155], v74 offset:4608
  v_mfma_f32_16x16x32_bf16 v[52:55], a[184:187], v[36:39], v[52:55]
  ds_read_b64_tr_b16 v[156:157], v75 offset:4096
  ds_read_b128 v[32:35], v7 offset:17408
  s_waitcnt lgkmcnt(9)
  v_mfma_f32_16x16x32_bf16 v[44:47], a[60:63], v[40:43], v[44:47]
  ds_read_b64_tr_b16 v[158:159], v75 offset:4608
  v_mfma_f32_16x16x32_bf16 v[48:51], a[124:127], v[40:43], v[48:51]
  v_mfma_f32_16x16x32_bf16 v[52:55], a[188:191], v[40:43], v[52:55]
  s_waitcnt lgkmcnt(0)
  s_add_u32 m0, s61, 4096
  ds_read_b128 v[36:39], v7 offset:18432
  v_mfma_f32_16x16x32_bf16 v[56:59], a[0:3], v[28:31], v[16:19]
  buffer_load_dwordx4 v68, s[48:51], s60 offen offset:0 lds
  v_mfma_f32_16x16x32_bf16 v[60:63], a[64:67], v[28:31], v[20:23]
  v_max_f32 v76, 0, v44
  v_max_f32 v77, 0, v45
  v_mfma_f32_16x16x32_bf16 v[64:67], a[128:131], v[28:31], v[24:27]
  v_mul_f32 v76, v76, v44
  ds_read_b128 v[40:43], v7 offset:19456
  v_mfma_f32_16x16x32_bf16 v[56:59], a[4:7], v[32:35], v[56:59]
  buffer_load_dwordx4 v69, s[48:51], s60 offen offset:1024 lds
  v_mfma_f32_16x16x32_bf16 v[60:63], a[68:71], v[32:35], v[60:63]
  v_mul_f32 v77, v77, v45
  v_cvt_pk_bf16_f32 v80, v76, v77
  v_mfma_f32_16x16x32_bf16 v[64:67], a[132:135], v[32:35], v[64:67]
  v_max_f32 v76, 0, v46
  ds_read_b128 v[28:31], v7 offset:20480
  s_waitcnt lgkmcnt(2)
  v_mfma_f32_16x16x32_bf16 v[56:59], a[8:11], v[36:39], v[56:59]
  buffer_load_dwordx4 v70, s[48:51], s60 offen offset:2048 lds
  v_mfma_f32_16x16x32_bf16 v[60:63], a[72:75], v[36:39], v[60:63]
  v_max_f32 v77, 0, v47
  v_mul_f32 v76, v76, v46
  v_mfma_f32_16x16x32_bf16 v[64:67], a[136:139], v[36:39], v[64:67]
  v_mul_f32 v77, v77, v47
  ds_read_b128 v[32:35], v7 offset:21504
  s_waitcnt lgkmcnt(2)
  v_mfma_f32_16x16x32_bf16 v[56:59], a[12:15], v[40:43], v[56:59]
  buffer_load_dwordx4 v71, s[48:51], s60 offen offset:3072 lds
  v_mfma_f32_16x16x32_bf16 v[60:63], a[76:79], v[40:43], v[60:63]
  v_cvt_pk_bf16_f32 v81, v76, v77
  v_max_f32 v76, 0, v48
  v_mfma_f32_16x16x32_bf16 v[64:67], a[140:143], v[40:43], v[64:67]
  v_max_f32 v77, 0, v49
  ds_read_b128 v[36:39], v7 offset:22528
  s_waitcnt lgkmcnt(2)
  v_mfma_f32_16x16x32_bf16 v[56:59], a[16:19], v[28:31], v[56:59]
  v_mul_f32 v76, v76, v48
  v_mul_f32 v77, v77, v49
  v_mfma_f32_16x16x32_bf16 v[60:63], a[80:83], v[28:31], v[60:63]
  v_cvt_pk_bf16_f32 v82, v76, v77
  v_max_f32 v76, 0, v50
  v_mfma_f32_16x16x32_bf16 v[64:67], a[144:147], v[28:31], v[64:67]
  v_max_f32 v77, 0, v51
  ds_read_b128 v[40:43], v7 offset:23552
  s_waitcnt lgkmcnt(2)
  v_mfma_f32_16x16x32_bf16 v[56:59], a[20:23], v[32:35], v[56:59]
  v_mul_f32 v76, v76, v50
  v_mul_f32 v77, v77, v51
  v_mfma_f32_16x16x32_bf16 v[60:63], a[84:87], v[32:35], v[60:63]
  v_cvt_pk_bf16_f32 v83, v76, v77
  buffer_store_dwordx4 v[80:83], v12, s[28:31], s16 offen
  v_mfma_f32_16x16x32_bf16 v[64:67], a[148:151], v[32:35], v[64:67]
  v_max_f32 v76, 0, v52
  ds_read_b128 v[28:31], v7 offset:24576
  s_waitcnt lgkmcnt(2)
  v_mfma_f32_16x16x32_bf16 v[56:59], a[24:27], v[36:39], v[56:59]
  v_max_f32 v77, 0, v53
  v_mul_f32 v76, v76, v52
  v_mfma_f32_16x16x32_bf16 v[60:63], a[88:91], v[36:39], v[60:63]
  v_mul_f32 v77, v77, v53
  v_cvt_pk_bf16_f32 v84, v76, v77
  v_mfma_f32_16x16x32_bf16 v[64:67], a[152:155], v[36:39], v[64:67]
  v_max_f32 v76, 0, v54
  ds_read_b128 v[32:35], v7 offset:25600
  s_waitcnt lgkmcnt(2)
  v_mfma_f32_16x16x32_bf16 v[56:59], a[28:31], v[40:43], v[56:59]
  v_max_f32 v77, 0, v55
  v_mul_f32 v76, v76, v54
  v_mfma_f32_16x16x32_bf16 v[60:63], a[92:95], v[40:43], v[60:63]
  v_mul_f32 v77, v77, v55
  v_cvt_pk_bf16_f32 v85, v76, v77
  v_mfma_f32_16x16x32_bf16 v[64:67], a[156:159], v[40:43], v[64:67]
  buffer_store_dwordx2 v[84:85], v12, s[28:31], s17 offen
  ds_read_b128 v[36:39], v7 offset:26624
  s_waitcnt lgkmcnt(2)
  v_mfma_f32_16x16x32_bf16 v[56:59], a[32:35], v[28:31], v[56:59]
  s_add_u32 s16, s16, 44032
  s_add_u32 s17, s17, 44032
  v_mfma_f32_16x16x32_bf16 v[60:63], a[96:99], v[28:31], v[60:63]
  s_add_u32 s60, s60, 32768
  s_waitcnt vmcnt(18)
  ds_read_b64_tr_b16 v[160:161], v72 offset:8192
  v_mfma_f32_16x16x32_bf16 v[64:67], a[160:163], v[28:31], v[64:67]
  ds_read_b64_tr_b16 v[162:163], v72 offset:8704
  ds_read_b128 v[40:43], v7 offset:27648
  s_waitcnt lgkmcnt(4)
  v_mfma_f32_16x16x32_bf16 v[56:59], a[36:39], v[32:35], v[56:59]
  ds_read_b64_tr_b16 v[164:165], v73 offset:8192
  ds_read_b64_tr_b16 v[166:167], v73 offset:8704
  v_mfma_f32_16x16x32_bf16 v[60:63], a[100:103], v[32:35], v[60:63]
  ds_read_b64_tr_b16 v[168:169], v74 offset:8192
  ds_read_b64_tr_b16 v[170:171], v74 offset:8704
  v_mfma_f32_16x16x32_bf16 v[64:67], a[164:167], v[32:35], v[64:67]
  ds_read_b64_tr_b16 v[172:173], v75 offset:8192
  ds_read_b128 v[28:31], v7 offset:28672
  s_waitcnt lgkmcnt(9)
  v_mfma_f32_16x16x32_bf16 v[56:59], a[40:43], v[36:39], v[56:59]
  ds_read_b64_tr_b16 v[174:175], v75 offset:8704
  v_mfma_f32_16x16x32_bf16 v[60:63], a[104:107], v[36:39], v[60:63]
  v_mfma_f32_16x16x32_bf16 v[64:67], a[168:171], v[36:39], v[64:67]
  s_waitcnt lgkmcnt(0)
  s_add_u32 m0, s61, 8192
  ds_read_b128 v[32:35], v7 offset:29696
  v_mfma_f32_16x16x32_bf16 v[56:59], a[44:47], v[40:43], v[56:59]
  buffer_load_dwordx4 v68, s[48:51], s60 offen offset:0 lds
  v_mfma_f32_16x16x32_bf16 v[60:63], a[108:111], v[40:43], v[60:63]
  v_mfma_f32_16x16x32_bf16 v[64:67], a[172:175], v[40:43], v[64:67]
  ds_read_b128 v[36:39], v7 offset:30720
  s_waitcnt vmcnt(15)
  s_barrier
  v_mfma_f32_16x16x32_bf16 v[56:59], a[48:51], v[28:31], v[56:59]
  buffer_load_dwordx4 v69, s[48:51], s60 offen offset:1024 lds
  v_mfma_f32_16x16x32_bf16 v[60:63], a[112:115], v[28:31], v[60:63]
  v_mfma_f32_16x16x32_bf16 v[64:67], a[176:179], v[28:31], v[64:67]
  ds_read_b128 v[40:43], v7 offset:31744
  s_waitcnt lgkmcnt(2)
  v_mfma_f32_16x16x32_bf16 v[56:59], a[52:55], v[32:35], v[56:59]
  buffer_load_dwordx4 v70, s[48:51], s60 offen offset:2048 lds
  v_mfma_f32_16x16x32_bf16 v[60:63], a[116:119], v[32:35], v[60:63]
  v_mfma_f32_16x16x32_bf16 v[64:67], a[180:183], v[32:35], v[64:67]
  s_waitcnt vmcnt(3)
  buffer_store_dword v4, v3, s[28:31], s12 offen offset:256
  ds_read_b128 v[28:31], v7 offset:32768
  s_waitcnt lgkmcnt(2)
  v_mfma_f32_16x16x32_bf16 v[56:59], a[56:59], v[36:39], v[56:59]
  buffer_load_dwordx4 v71, s[48:51], s60 offen offset:3072 lds
  v_mfma_f32_16x16x32_bf16 v[60:63], a[120:123], v[36:39], v[60:63]
  s_add_u32 s56, s18, 0
  s_add_u32 s66, s13, 0
  v_mfma_f32_16x16x32_bf16 v[64:67], a[184:187], v[36:39], v[64:67]
  s_add_u32 s60, s60, 32768
  ds_read_b128 v[32:35], v7 offset:33792
  s_waitcnt lgkmcnt(2)
  v_mfma_f32_16x16x32_bf16 v[56:59], a[60:63], v[40:43], v[56:59]
  ds_read_b64_tr_b16 v[176:177], v72 offset:0
  ds_read_b64_tr_b16 v[178:179], v72 offset:512
  v_mfma_f32_16x16x32_bf16 v[60:63], a[124:127], v[40:43], v[60:63]
  ds_read_b64_tr_b16 v[180:181], v73 offset:0
  ds_read_b64_tr_b16 v[182:183], v73 offset:512
  v_mfma_f32_16x16x32_bf16 v[64:67], a[188:191], v[40:43], v[64:67]
  ds_read_b64_tr_b16 v[184:185], v74 offset:0
  ds_read_b128 v[36:39], v7 offset:34816
  s_waitcnt lgkmcnt(7)
  v_mfma_f32_16x16x32_bf16 v[44:47], a[0:3], v[28:31], v[16:19]
  ds_read_b64_tr_b16 v[186:187], v74 offset:512
  ds_read_b64_tr_b16 v[188:189], v75 offset:0
  v_mfma_f32_16x16x32_bf16 v[48:51], a[64:67], v[28:31], v[20:23]
  v_max_f32 v76, 0, v56
  v_max_f32 v77, 0, v57
  v_mfma_f32_16x16x32_bf16 v[52:55], a[128:131], v[28:31], v[24:27]
  v_mul_f32 v76, v76, v56
  ds_read_b128 v[40:43], v7 offset:35840
  s_waitcnt lgkmcnt(9)
  v_mfma_f32_16x16x32_bf16 v[44:47], a[4:7], v[32:35], v[44:47]
  v_mul_f32 v77, v77, v57
  v_cvt_pk_bf16_f32 v80, v76, v77
  v_mfma_f32_16x16x32_bf16 v[48:51], a[68:71], v[32:35], v[48:51]
  v_max_f32 v76, 0, v58
  v_max_f32 v77, 0, v59
  v_mfma_f32_16x16x32_bf16 v[52:55], a[132:135], v[32:35], v[52:55]
  v_mul_f32 v76, v76, v58
  ds_read_b128 v[28:31], v7 offset:36864
  s_waitcnt lgkmcnt(4)
  v_mfma_f32_16x16x32_bf16 v[44:47], a[8:11], v[36:39], v[44:47]
  v_mul_f32 v77, v77, v59
  v_cvt_pk_bf16_f32 v81, v76, v77
  v_mfma_f32_16x16x32_bf16 v[48:51], a[72:75], v[36:39], v[48:51]
  v_max_f32 v76, 0, v60
  v_max_f32 v77, 0, v61
  v_mfma_f32_16x16x32_bf16 v[52:55], a[136:139], v[36:39], v[52:55]
  v_mul_f32 v76, v76, v60
  ds_read_b128 v[32:35], v7 offset:37888
  s_waitcnt lgkmcnt(2)
  v_mfma_f32_16x16x32_bf16 v[44:47], a[12:15], v[40:43], v[44:47]
  v_mul_f32 v77, v77, v61
  v_cvt_pk_bf16_f32 v82, v76, v77
  v_mfma_f32_16x16x32_bf16 v[48:51], a[76:79], v[40:43], v[48:51]
  v_max_f32 v76, 0, v62
  v_max_f32 v77, 0, v63
  v_mfma_f32_16x16x32_bf16 v[52:55], a[140:143], v[40:43], v[52:55]
  v_mul_f32 v76, v76, v62
  ds_read_b128 v[36:39], v7 offset:38912
  s_waitcnt lgkmcnt(2)
  v_mfma_f32_16x16x32_bf16 v[44:47], a[16:19], v[28:31], v[44:47]
  v_mul_f32 v77, v77, v63
  v_cvt_pk_bf16_f32 v83, v76, v77
  v_mfma_f32_16x16x32_bf16 v[48:51], a[80:83], v[28:31], v[48:51]
  buffer_store_dwordx4 v[80:83], v12, s[28:31], s16 offen
  v_mfma_f32_16x16x32_bf16 v[52:55], a[144:147], v[28:31], v[52:55]
  v_max_f32 v76, 0, v64
  ds_read_b128 v[40:43], v7 offset:39936
  s_waitcnt lgkmcnt(2)
  v_mfma_f32_16x16x32_bf16 v[44:47], a[20:23], v[32:35], v[44:47]
  v_max_f32 v77, 0, v65
  v_mul_f32 v76, v76, v64
  v_mfma_f32_16x16x32_bf16 v[48:51], a[84:87], v[32:35], v[48:51]
  buffer_load_dword v6, v5, s[28:31], s65 offen offset:256 sc1
  v_mul_f32 v77, v77, v65
  v_mfma_f32_16x16x32_bf16 v[52:55], a[148:151], v[32:35], v[52:55]
  v_cvt_pk_bf16_f32 v84, v76, v77
  ds_read_b128 v[28:31], v7 offset:40960
  s_waitcnt lgkmcnt(2)
  v_mfma_f32_16x16x32_bf16 v[44:47], a[24:27], v[36:39], v[44:47]
  v_max_f32 v76, 0, v66
  v_max_f32 v77, 0, v67
  v_mfma_f32_16x16x32_bf16 v[48:51], a[88:91], v[36:39], v[48:51]
  v_mul_f32 v76, v76, v66
  v_mul_f32 v77, v77, v67
  v_mfma_f32_16x16x32_bf16 v[52:55], a[152:155], v[36:39], v[52:55]
  v_cvt_pk_bf16_f32 v85, v76, v77
  ds_read_b128 v[32:35], v7 offset:41984
  s_waitcnt lgkmcnt(2)
  v_mfma_f32_16x16x32_bf16 v[44:47], a[28:31], v[40:43], v[44:47]
  buffer_store_dwordx2 v[84:85], v12, s[28:31], s17 offen
  v_mfma_f32_16x16x32_bf16 v[48:51], a[92:95], v[40:43], v[48:51]
  s_add_u32 s16, s16, 44032
  s_add_u32 s17, s17, 44032
  v_mfma_f32_16x16x32_bf16 v[52:55], a[156:159], v[40:43], v[52:55]
  ds_read_b64_tr_b16 v[190:191], v75 offset:512
  ds_read_b128 v[36:39], v7 offset:43008
  s_waitcnt lgkmcnt(3)
  v_mfma_f32_16x16x32_bf16 v[44:47], a[32:35], v[28:31], v[44:47]
  v_mfma_f32_16x16x32_bf16 v[48:51], a[96:99], v[28:31], v[48:51]
  v_mfma_f32_16x16x32_bf16 v[52:55], a[160:163], v[28:31], v[52:55]
  s_waitcnt lgkmcnt(1)
  s_add_u32 m0, s61, 0
  ds_read_b128 v[40:43], v7 offset:44032
  v_mfma_f32_16x16x32_bf16 v[44:47], a[36:39], v[32:35], v[44:47]
  buffer_load_dwordx4 v68, s[48:51], s60 offen offset:0 lds
  v_mfma_f32_16x16x32_bf16 v[48:51], a[100:103], v[32:35], v[48:51]
  v_mfma_f32_16x16x32_bf16 v[52:55], a[164:167], v[32:35], v[52:55]
  ds_read_b128 v[28:31], v7 offset:45056
  s_waitcnt lgkmcnt(2)
  v_mfma_f32_16x16x32_bf16 v[44:47], a[40:43], v[36:39], v[44:47]
  buffer_load_dwordx4 v69, s[48:51], s60 offen offset:1024 lds
  v_mfma_f32_16x16x32_bf16 v[48:51], a[104:107], v[36:39], v[48:51]
  s_waitcnt vmcnt(3)
  v_cmp_ne_u32 vcc, s71, v6
  s_nop 1
  s_cbranch_vccnz pf40_retry
pf40_ok:
  v_mfma_f32_16x16x32_bf16 v[52:55], a[168:171], v[36:39], v[52:55]
  ds_read_b128 v[32:35], v7 offset:46080
  s_waitcnt lgkmcnt(2)
  v_mfma_f32_16x16x32_bf16 v[44:47], a[44:47], v[40:43], v[44:47]
  buffer_load_dwordx4 v70, s[48:51], s60 offen offset:2048 lds
  v_mfma_f32_16x16x32_bf16 v[48:51], a[108:111], v[40:43], v[48:51]
  v_mfma_f32_16x16x32_bf16 v[52:55], a[172:175], v[40:43], v[52:55]
  ds_read_b128 v[36:39], v7 offset:47104
  s_barrier
  s_waitcnt lgkmcnt(2)
  v_mfma_f32_16x16x32_bf16 v[44:47], a[48:51], v[28:31], v[44:47]
  buffer_load_dwordx4 v71, s[48:51], s60 offen offset:3072 lds
  v_mfma_f32_16x16x32_bf16 v[48:51], a[112:115], v[28:31], v[48:51]
  s_add_u32 s60, s60, 32768
  ds_read_b64_tr_b16 v[192:193], v72 offset:4096
  v_mfma_f32_16x16x32_bf16 v[52:55], a[176:179], v[28:31], v[52:55]
  ds_read_b64_tr_b16 v[194:195], v72 offset:4608
  ds_read_b128 v[40:43], v7 offset:48128
  s_waitcnt lgkmcnt(4)
  v_mfma_f32_16x16x32_bf16 v[44:47], a[52:55], v[32:35], v[44:47]
  buffer_load_dwordx4 v[88:91], v12, s[28:31], s56 offen offset:0 sc1
  v_mfma_f32_16x16x32_bf16 v[48:51], a[116:119], v[32:35], v[48:51]
  s_waitcnt vmcnt(5)
  buffer_store_dword v4, v3, s[28:31], s12 offen offset:384
  s_add_u32 s57, s18, 44032
  v_mfma_f32_16x16x32_bf16 v[52:55], a[180:183], v[32:35], v[52:55]
  s_add_u32 s67, s13, 44032
  ds_read_b128 v[28:31], v7 offset:49152
  s_waitcnt lgkmcnt(4)
  v_mfma_f32_16x16x32_bf16 v[44:47], a[56:59], v[36:39], v[44:47]
  buffer_load_dwordx4 v[92:95], v12, s[28:31], s56 offen offset:1024 sc1
  v_mfma_f32_16x16x32_bf16 v[48:51], a[120:123], v[36:39], v[48:51]
  ds_read_b64_tr_b16 v[196:197], v73 offset:4096
  ds_read_b64_tr_b16 v[198:199], v73 offset:4608
  v_mfma_f32_16x16x32_bf16 v[52:55], a[184:187], v[36:39], v[52:55]
  ds_read_b64_tr_b16 v[200:201], v74 offset:4096
  ds_read_b128 v[32:35], v7 offset:50176
  s_waitcnt lgkmcnt(5)
  v_mfma_f32_16x16x32_bf16 v[44:47], a[60:63], v[40:43], v[44:47]
  buffer_load_dwordx4 v[96:99], v12, s[28:31], s56 offen offset:2048 sc1
  v_mfma_f32_16x16x32_bf16 v[48:51], a[124:127], v[40:43], v[48:51]
  ds_read_b64_tr_b16 v[202:203], v74 offset:4608
  ds_read_b64_tr_b16 v[204:205], v75 offset:4096
  v_mfma_f32_16x16x32_bf16 v[52:55], a[188:191], v[40:43], v[52:55]
  ds_read_b64_tr_b16 v[206:207], v75 offset:4608
  ds_read_b128 v[36:39], v7 offset:51200
  s_waitcnt lgkmcnt(8)
  v_mfma_f32_16x16x32_bf16 v[56:59], a[0:3], v[28:31], v[16:19]
  buffer_load_dwordx4 v[100:103], v12, s[28:31], s56 offen offset:3072 sc1
  v_mfma_f32_16x16x32_bf16 v[60:63], a[64:67], v[28:31], v[20:23]
  v_max_f32 v76, 0, v44
  v_max_f32 v77, 0, v45
  v_mfma_f32_16x16x32_bf16 v[64:67], a[128:131], v[28:31], v[24:27]
  s_waitcnt lgkmcnt(1)
  s_add_u32 m0, s61, 4096
  ds_read_b128 v[40:43], v7 offset:52224
  v_mfma_f32_16x16x32_bf16 v[56:59], a[4:7], v[32:35], v[56:59]
  buffer_load_dwordx4 v68, s[48:51], s60 offen offset:0 lds
  v_mfma_f32_16x16x32_bf16 v[60:63], a[68:71], v[32:35], v[60:63]
  v_mul_f32 v76, v76, v44
  v_mul_f32 v77, v77, v45
  v_mfma_f32_16x16x32_bf16 v[64:67], a[132:135], v[32:35], v[64:67]
  v_cvt_pk_bf16_f32 v80, v76, v77
  ds_read_b128 v[28:31], v7 offset:53248
  s_waitcnt lgkmcnt(2)
  v_mfma_f32_16x16x32_bf16 v[56:59], a[8:11], v[36:39], v[56:59]
  buffer_load_dwordx4 v69, s[48:51], s60 offen offset:1024 lds
  v_mfma_f32_16x16x32_bf16 v[60:63], a[72:75], v[36:39], v[60:63]
  v_max_f32 v76, 0, v46
  v_max_f32 v77, 0, v47
  v_mfma_f32_16x16x32_bf16 v[64:67], a[136:139], v[36:39], v[64:67]
  v_mul_f32 v76, v76, v46
  ds_read_b128 v[32:35], v7 offset:54272
  s_waitcnt lgkmcnt(2)
  v_mfma_f32_16x16x32_bf16 v[56:59], a[12:15], v[40:43], v[56:59]
  buffer_load_dwordx4 v70, s[48:51], s60 offen offset:2048 lds
  v_mfma_f32_16x16x32_bf16 v[60:63], a[76:79], v[40:43], v[60:63]
  v_mul_f32 v77, v77, v47
  v_cvt_pk_bf16_f32 v81, v76, v77
  v_mfma_f32_16x16x32_bf16 v[64:67], a[140:143], v[40:43], v[64:67]
  v_max_f32 v76, 0, v48
  ds_read_b128 v[36:39], v7 offset:55296
  s_waitcnt lgkmcnt(2)
  v_mfma_f32_16x16x32_bf16 v[56:59], a[16:19], v[28:31], v[56:59]
  buffer_load_dwordx4 v71, s[48:51], s60 offen offset:3072 lds
  v_mfma_f32_16x16x32_bf16 v[60:63], a[80:83], v[28:31], v[60:63]
  v_max_f32 v77, 0, v49
  v_mul_f32 v76, v76, v48
  v_mfma_f32_16x16x32_bf16 v[64:67], a[144:147], v[28:31], v[64:67]
  buffer_load_dword v6, v5, s[28:31], s65 offen offset:384 sc1
  ds_read_b128 v[40:43], v7 offset:56320
  s_waitcnt lgkmcnt(2)
  v_mfma_f32_16x16x32_bf16 v[56:59], a[20:23], v[32:35], v[56:59]
  buffer_load_dwordx4 v[104:107], v13, s[28:31], s56 offen offset:0 sc1
  v_mfma_f32_16x16x32_bf16 v[60:63], a[84:87], v[32:35], v[60:63]
  v_mul_f32 v77, v77, v49
  v_cvt_pk_bf16_f32 v82, v76, v77
  v_mfma_f32_16x16x32_bf16 v[64:67], a[148:151], v[32:35], v[64:67]
  v_max_f32 v76, 0, v50
  ds_read_b128 v[28:31], v7 offset:57344
  s_waitcnt lgkmcnt(2)
  v_mfma_f32_16x16x32_bf16 v[56:59], a[24:27], v[36:39], v[56:59]
  buffer_load_dwordx4 v[108:111], v13, s[28:31], s56 offen offset:1024 sc1
  v_mfma_f32_16x16x32_bf16 v[60:63], a[88:91], v[36:39], v[60:63]
  v_max_f32 v77, 0, v51
  v_mul_f32 v76, v76, v50
  v_mfma_f32_16x16x32_bf16 v[64:67], a[152:155], v[36:39], v[64:67]
  v_mul_f32 v77, v77, v51
  ds_read_b128 v[32:35], v7 offset:58368
  s_waitcnt lgkmcnt(2)
  v_mfma_f32_16x16x32_bf16 v[56:59], a[28:31], v[40:43], v[56:59]
  buffer_load_dwordx4 v[112:115], v13, s[28:31], s56 offen offset:2048 sc1
  v_mfma_f32_16x16x32_bf16 v[60:63], a[92:95], v[40:43], v[60:63]
  v_cvt_pk_bf16_f32 v83, v76, v77
  s_add_u32 s60, s60, 32768
  v_mfma_f32_16x16x32_bf16 v[64:67], a[156:159], v[40:43], v[64:67]
  ds_read_b64_tr_b16 v[208:209], v72 offset:8192
  ds_read_b128 v[36:39], v7 offset:59392
  s_waitcnt lgkmcnt(3)
  v_mfma_f32_16x16x32_bf16 v[56:59], a[32:35], v[28:31], v[56:59]
  buffer_store_dwordx4 v[80:83], v12, s[28:31], s16 offen
  v_mfma_f32_16x16x32_bf16 v[60:63], a[96:99], v[28:31], v[60:63]
  v_max_f32 v76, 0, v52
  v_max_f32 v77, 0, v53
  v_mfma_f32_16x16x32_bf16 v[64:67], a[160:163], v[28:31], v[64:67]
  v_mul_f32 v76, v76, v52
  ds_read_b128 v[40:43], v7 offset:60416
  s_waitcnt lgkmcnt(3)
  v_mfma_f32_16x16x32_bf16 v[56:59], a[36:39], v[32:35], v[56:59]
  buffer_load_dwordx4 v[116:119], v13, s[28:31], s56 offen offset:3072 sc1
  v_mfma_f32_16x16x32_bf16 v[60:63], a[100:103], v[32:35], v[60:63]
  v_mul_f32 v77, v77, v53
  v_cvt_pk_bf16_f32 v84, v76, v77
  v_mfma_f32_16x16x32_bf16 v[64:67], a[164:167], v[32:35], v[64:67]
  s_waitcnt vmcnt(5)
  v_cmp_ne_u32 vcc, s71, v6
  s_nop 1
  s_cbranch_vccnz pf41_retry
pf41_ok:
  ds_read_b128 v[28:31], v7 offset:61440
  s_waitcnt lgkmcnt(2)
  v_mfma_f32_16x16x32_bf16 v[56:59], a[40:43], v[36:39], v[56:59]
  buffer_load_dwordx4 v[120:123], v14, s[28:31], s56 offen offset:0 sc1
  v_mfma_f32_16x16x32_bf16 v[60:63], a[104:107], v[36:39], v[60:63]
  v_max_f32 v76, 0, v54
  v_max_f32 v77, 0, v55
  v_mfma_f32_16x16x32_bf16 v[64:67], a[168:171], v[36:39], v[64:67]
  v_mul_f32 v76, v76, v54
  ds_read_b128 v[32:35], v7 offset:62464
  s_waitcnt lgkmcnt(2)
  v_mfma_f32_16x16x32_bf16 v[56:59], a[44:47], v[40:43], v[56:59]
  buffer_load_dwordx4 v[124:127], v14, s[28:31], s56 offen offset:1024 sc1
  v_mfma_f32_16x16x32_bf16 v[60:63], a[108:111], v[40:43], v[60:63]
  v_mul_f32 v77, v77, v55
  v_cvt_pk_bf16_f32 v85, v76, v77
  v_mfma_f32_16x16x32_bf16 v[64:67], a[172:175], v[40:43], v[64:67]
  ds_read_b64_tr_b16 v[210:211], v72 offset:8704
  ds_read_b128 v[36:39], v7 offset:63488
  s_waitcnt lgkmcnt(3)
  v_mfma_f32_16x16x32_bf16 v[56:59], a[48:51], v[28:31], v[56:59]
  buffer_store_dwordx2 v[84:85], v12, s[28:31], s17 offen
  v_mfma_f32_16x16x32_bf16 v[60:63], a[112:115], v[28:31], v[60:63]
  s_add_u32 s16, s16, 44032
  s_add_u32 s17, s17, 44032
  v_mfma_f32_16x16x32_bf16 v[64:67], a[176:179], v[28:31], v[64:67]
  ds_read_b64_tr_b16 v[212:213], v73 offset:8192
  ds_read_b128 v[40:43], v7 offset:64512
  s_waitcnt lgkmcnt(4)
  v_mfma_f32_16x16x32_bf16 v[56:59], a[52:55], v[32:35], v[56:59]
  buffer_load_dwordx4 v[128:131], v14, s[28:31], s66 offen offset:2048 sc1
  v_mfma_f32_16x16x32_bf16 v[60:63], a[116:119], v[32:35], v[60:63]
  ds_read_b64_tr_b16 v[214:215], v73 offset:8704
  ds_read_b64_tr_b16 v[216:217], v74 offset:8192
  v_mfma_f32_16x16x32_bf16 v[64:67], a[180:183], v[32:35], v[64:67]
  ds_read_b64_tr_b16 v[218:219], v74 offset:8704
  ds_read_b64_tr_b16 v[220:221], v75 offset:8192
  s_waitcnt lgkmcnt(6)
  v_mfma_f32_16x16x32_bf16 v[56:59], a[56:59], v[36:39], v[56:59]
  buffer_load_dwordx4 a[0:3], v12, s[28:31], s57 offen offset:0 sc1
  v_mfma_f32_16x16x32_bf16 v[60:63], a[120:123], v[36:39], v[60:63]
  ds_read_b64_tr_b16 v[222:223], v75 offset:8704
  v_mfma_f32_16x16x32_bf16 v[64:67], a[184:187], v[36:39], v[64:67]
  s_waitcnt lgkmcnt(5)
  v_mfma_f32_16x16x32_bf16 v[56:59], a[60:63], v[40:43], v[56:59]
  buffer_load_dwordx4 a[4:7], v12, s[28:31], s57 offen offset:1024 sc1
  v_mfma_f32_16x16x32_bf16 v[60:63], a[124:127], v[40:43], v[60:63]
  ds_read_b64_tr_b16 v[224:225], v72 offset:0
  ds_read_b64_tr_b16 v[226:227], v72 offset:512
  v_mfma_f32_16x16x32_bf16 v[64:67], a[188:191], v[40:43], v[64:67]
  ds_read_b64_tr_b16 v[228:229], v73 offset:0
  ds_read_b64_tr_b16 v[230:231], v73 offset:512
  v_mfma_f32_16x16x32_bf16 v[16:19], a[192:195], v[88:91], 0
  buffer_load_dwordx4 a[8:11], v12, s[28:31], s57 offen offset:2048 sc1
  v_mfma_f32_16x16x32_bf16 v[20:23], a[196:199], v[88:91], 0
  v_max_f32 v76, 0, v56
  v_max_f32 v77, 0, v57
  v_mfma_f32_16x16x32_bf16 v[24:27], a[200:203], v[88:91], 0
  v_mul_f32 v76, v76, v56
  v_mul_f32 v77, v77, v57
  v_mfma_f32_16x16x32_bf16 v[28:31], a[204:207], v[88:91], 0
  buffer_load_dwordx4 a[12:15], v12, s[28:31], s57 offen offset:3072 sc1
  v_mfma_f32_16x16x32_bf16 v[16:19], a[208:211], v[92:95], v[16:19]
  v_cvt_pk_bf16_f32 v80, v76, v77
  v_max_f32 v76, 0, v58
  v_mfma_f32_16x16x32_bf16 v[20:23], a[212:215], v[92:95], v[20:23]
  v_max_f32 v77, 0, v59
  v_mul_f32 v76, v76, v58
  v_mfma_f32_16x16x32_bf16 v[24:27], a[216:219], v[92:95], v[24:27]
  buffer_load_dwordx4 a[16:19], v13, s[28:31], s57 offen offset:0 sc1
  v_mfma_f32_16x16x32_bf16 v[28:31], a[220:223], v[92:95], v[28:31]
  s_waitcnt vmcnt(6)
  buffer_store_dword v4, v3, s[28:31], s12 offen offset:512
  s_add_u32 s58, s18, 88064
  v_mfma_f32_16x16x32_bf16 v[16:19], a[224:227], v[96:99], v[16:19]
  s_add_u32 s68, s13, 88064
  v_mul_f32 v77, v77, v59
  v_mfma_f32_16x16x32_bf16 v[20:23], a[228:231], v[96:99], v[20:23]
  buffer_load_dwordx4 a[20:23], v13, s[28:31], s57 offen offset:1024 sc1
  v_mfma_f32_16x16x32_bf16 v[24:27], a[232:235], v[96:99], v[24:27]
  v_cvt_pk_bf16_f32 v81, v76, v77
  v_max_f32 v76, 0, v60
  v_mfma_f32_16x16x32_bf16 v[28:31], a[236:239], v[96:99], v[28:31]
  v_max_f32 v77, 0, v61
  v_mul_f32 v76, v76, v60
  v_mfma_f32_16x16x32_bf16 v[16:19], a[240:243], v[100:103], v[16:19]
  buffer_load_dwordx4 a[24:27], v13, s[28:31], s57 offen offset:2048 sc1
  v_mfma_f32_16x16x32_bf16 v[20:23], a[244:247], v[100:103], v[20:23]
  v_mul_f32 v77, v77, v61
  v_cvt_pk_bf16_f32 v82, v76, v77
  v_mfma_f32_16x16x32_bf16 v[24:27], a[248:251], v[100:103], v[24:27]
  v_max_f32 v76, 0, v62
  v_max_f32 v77, 0, v63
  v_mfma_f32_16x16x32_bf16 v[28:31], a[252:255], v[100:103], v[28:31]
  buffer_load_dwordx4 a[28:31], v13, s[28:31], s57 offen offset:3072 sc1
  v_mfma_f32_16x16x32_bf16 v[16:19], v[144:147], v[104:107], v[16:19]
  v_mul_f32 v76, v76, v62
  v_mul_f32 v77, v77, v63
  v_mfma_f32_16x16x32_bf16 v[20:23], v[148:151], v[104:107], v[20:23]
  v_cvt_pk_bf16_f32 v83, v76, v77
  ds_read_b64_tr_b16 v[232:233], v74 offset:0
  v_mfma_f32_16x16x32_bf16 v[24:27], v[152:155], v[104:107], v[24:27]
  buffer_store_dwordx4 v[80:83], v12, s[28:31], s16 offen
  v_mfma_f32_16x16x32_bf16 v[28:31], v[156:159], v[104:107], v[28:31]
  v_max_f32 v76, 0, v64
  v_max_f32 v77, 0, v65
  v_mfma_f32_16x16x32_bf16 v[16:19], v[160:163], v[108:111], v[16:19]
  v_mul_f32 v76, v76, v64
  v_mul_f32 v77, v77, v65
  v_mfma_f32_16x16x32_bf16 v[20:23], v[164:167], v[108:111], v[20:23]
  buffer_load_dwordx4 a[32:35], v14, s[28:31], s57 offen offset:0 sc1
  v_mfma_f32_16x16x32_bf16 v[24:27], v[168:171], v[108:111], v[24:27]
  v_cvt_pk_bf16_f32 v84, v76, v77
  v_max_f32 v76, 0, v66
  v_mfma_f32_16x16x32_bf16 v[28:31], v[172:175], v[108:111], v[28:31]
  v_max_f32 v77, 0, v67
  v_mul_f32 v76, v76, v66
  v_mfma_f32_16x16x32_bf16 v[16:19], v[176:179], v[112:115], v[16:19]
  buffer_load_dwordx4 a[36:39], v14, s[28:31], s57 offen offset:1024 sc1
  v_mfma_f32_16x16x32_bf16 v[20:23], v[180:183], v[112:115], v[20:23]
  v_mul_f32 v77, v77, v67
  v_cvt_pk_bf16_f32 v85, v76, v77
  v_mfma_f32_16x16x32_bf16 v[24:27], v[184:187], v[112:115], v[24:27]
  ds_read_b64_tr_b16 v[234:235], v74 offset:512
  ds_read_b64_tr_b16 v[236:237], v75 offset:0
  v_mfma_f32_16x16x32_bf16 v[28:31], v[188:191], v[112:115], v[28:31]
  buffer_store_dwordx2 v[84:85], v12, s[28:31], s17 offen
  v_mfma_f32_16x16x32_bf16 v[16:19], v[192:195], v[116:119], v[16:19]
  buffer_load_dword v6, v5, s[28:31], s65 offen offset:512 sc1
  ds_read_b64_tr_b16 v[238:239], v75 offset:512
  v_mfma_f32_16x16x32_bf16 v[20:23], v[196:199], v[116:119], v[20:23]
  v_mfma_f32_16x16x32_bf16 v[24:27], v[200:203], v[116:119], v[24:27]
  buffer_load_dwordx4 a[40:43], v14, s[28:31], s67 offen offset:2048 sc1
  v_mfma_f32_16x16x32_bf16 v[28:31], v[204:207], v[116:119], v[28:31]
  ds_read_b64_tr_b16 v[240:241], v72 offset:4096
  s_waitcnt lgkmcnt(12)
  ds_read_b64_tr_b16 v[242:243], v72 offset:4608
  v_mfma_f32_16x16x32_bf16 v[16:19], v[208:211], v[120:123], v[16:19]
  ds_read_b64_tr_b16 v[244:245], v73 offset:4096
  s_waitcnt lgkmcnt(12)
  ds_read_b64_tr_b16 v[246:247], v73 offset:4608
  v_mfma_f32_16x16x32_bf16 v[20:23], v[212:215], v[120:123], v[20:23]
  ds_read_b64_tr_b16 v[248:249], v74 offset:4096
  s_waitcnt lgkmcnt(12)
  ds_read_b64_tr_b16 v[250:251], v74 offset:4608
  v_mfma_f32_16x16x32_bf16 v[24:27], v[216:219], v[120:123], v[24:27]
  ds_read_b64_tr_b16 v[252:253], v75 offset:4096
  s_waitcnt lgkmcnt(12)
  ds_read_b64_tr_b16 v[254:255], v75 offset:4608
  v_mfma_f32_16x16x32_bf16 v[28:31], v[220:223], v[120:123], v[28:31]
  v_mfma_f32_16x16x32_bf16 v[16:19], v[224:227], v[124:127], v[16:19]
  s_waitcnt lgkmcnt(12)
  v_mfma_f32_16x16x32_bf16 v[20:23], v[228:231], v[124:127], v[20:23]
  s_waitcnt lgkmcnt(10)
  v_mfma_f32_16x16x32_bf16 v[24:27], v[232:235], v[124:127], v[24:27]
  s_waitcnt lgkmcnt(8)
  v_mfma_f32_16x16x32_bf16 v[28:31], v[236:239], v[124:127], v[28:31]
  s_waitcnt vmcnt(15)
  s_waitcnt lgkmcnt(6)
  v_mfma_f32_16x16x32_bf16 v[16:19], v[240:243], v[128:131], v[16:19]
  s_waitcnt lgkmcnt(4)
  v_mfma_f32_16x16x32_bf16 v[20:23], v[244:247], v[128:131], v[20:23]
  s_waitcnt lgkmcnt(2)
  v_mfma_f32_16x16x32_bf16 v[24:27], v[248:251], v[128:131], v[24:27]
  s_waitcnt vmcnt(1)
  v_cmp_ne_u32 vcc, s71, v6
  s_nop 1
  s_cbranch_vccnz pf42_retry
pf42_ok:
  s_waitcnt lgkmcnt(0)
  v_mfma_f32_16x16x32_bf16 v[28:31], v[252:255], v[128:131], v[28:31]
  buffer_load_dwordx4 a[44:47], v12, s[28:31], s58 offen offset:0 sc1
  v_mfma_f32_16x16x32_bf16 v[32:35], a[192:195], a[0:3], 0
  buffer_store_dword v4, v3, s[28:31], s12 offen offset:640
  s_add_u32 s59, s18, 132096
  v_mfma_f32_16x16x32_bf16 v[36:39], a[196:199], a[0:3], 0
  s_add_u32 s69, s13, 132096
  ds_write_b128 v10, v[16:19] offset:0
  v_mfma_f32_16x16x32_bf16 v[40:43], a[200:203], a[0:3], 0
  buffer_load_dwordx4 a[48:51], v12, s[28:31], s58 offen offset:1024 sc1
  v_mfma_f32_16x16x32_bf16 v[44:47], a[204:207], a[0:3], 0
  ds_write_b128 v10, v[20:23] offset:1312
  v_mfma_f32_16x16x32_bf16 v[32:35], a[208:211], a[4:7], v[32:35]
  ds_write_b128 v10, v[24:27] offset:2624
  v_mfma_f32_16x16x32_bf16 v[36:39], a[212:215], a[4:7], v[36:39]
  buffer_load_dwordx4 a[52:55], v12, s[28:31], s58 offen offset:2048 sc1
  v_mfma_f32_16x16x32_bf16 v[40:43], a[216:219], a[4:7], v[40:43]
  ds_write_b128 v10, v[28:31] offset:3936
  v_mfma_f32_16x16x32_bf16 v[44:47], a[220:223], a[4:7], v[44:47]
  ds_read_b32 v66, v15 offset:0
  ds_read_b32 v67, v15 offset:2048
  v_mfma_f32_16x16x32_bf16 v[32:35], a[224:227], a[8:11], v[32:35]
  buffer_load_dwordx4 a[56:59], v12, s[28:31], s58 offen offset:3072 sc1
  v_mfma_f32_16x16x32_bf16 v[36:39], a[228:231], a[8:11], v[36:39]
  v_mfma_f32_16x16x32_bf16 v[40:43], a[232:235], a[8:11], v[40:43]
  v_mfma_f32_16x16x32_bf16 v[44:47], a[236:239], a[8:11], v[44:47]
  buffer_load_dwordx4 a[60:63], v13, s[28:31], s58 offen offset:0 sc1
  v_mfma_f32_16x16x32_bf16 v[32:35], a[240:243], a[12:15], v[32:35]
  s_waitcnt lgkmcnt(0)
  s_barrier
  ds_read_b128 v[48:51], v11 offset:0
  v_mfma_f32_16x16x32_bf16 v[36:39], a[244:247], a[12:15], v[36:39]
  ds_read_b128 v[52:55], v11 offset:5248
  ds_read_b128 v[56:59], v11 offset:10496
  v_mfma_f32_16x16x32_bf16 v[40:43], a[248:251], a[12:15], v[40:43]
  buffer_load_dwordx4 a[64:67], v13, s[28:31], s58 offen offset:1024 sc1
  v_mfma_f32_16x16x32_bf16 v[44:47], a[252:255], a[12:15], v[44:47]
  ds_read_b128 v[60:63], v11 offset:15744
  v_lshlrev_b32 v64, 16, v66
  v_mfma_f32_16x16x32_bf16 v[32:35], v[144:147], a[16:19], v[32:35]
  v_and_b32 v65, 0xffff0000, v66
  v_lshlrev_b32 v66, 16, v67
  v_mfma_f32_16x16x32_bf16 v[36:39], v[148:151], a[16:19], v[36:39]
  buffer_load_dwordx4 a[68:71], v13, s[28:31], s58 offen offset:2048 sc1
  v_mfma_f32_16x16x32_bf16 v[40:43], v[152:155], a[16:19], v[40:43]
  v_and_b32 v67, 0xffff0000, v67
  v_fma_f32 v64, v64, v137, v136
  v_mfma_f32_16x16x32_bf16 v[44:47], v[156:159], a[16:19], v[44:47]
  v_fma_f32 v65, v65, v137, v136
  v_fma_f32 v66, v66, v137, v136
  v_mfma_f32_16x16x32_bf16 v[32:35], v[160:163], a[20:23], v[32:35]
  buffer_load_dwordx4 a[72:75], v13, s[28:31], s58 offen offset:3072 sc1
  v_mfma_f32_16x16x32_bf16 v[36:39], v[164:167], a[20:23], v[36:39]
  buffer_load_dword v6, v5, s[28:31], s65 offen offset:640 sc1
  v_fma_f32 v67, v67, v137, v136
  v_mfma_f32_16x16x32_bf16 v[40:43], v[168:171], a[20:23], v[40:43]
  v_add_f32 v64, v64, v132
  v_add_f32 v65, v65, v133
  v_mfma_f32_16x16x32_bf16 v[44:47], v[172:175], a[20:23], v[44:47]
  buffer_load_dwordx4 a[76:79], v14, s[28:31], s58 offen offset:0 sc1
  v_mfma_f32_16x16x32_bf16 v[32:35], v[176:179], a[24:27], v[32:35]
  v_add_f32 v66, v66, v134
  v_add_f32 v67, v67, v135
  v_mfma_f32_16x16x32_bf16 v[36:39], v[180:183], a[24:27], v[36:39]
  s_waitcnt lgkmcnt(2)
  v_add_f32 v48, v48, v52
  v_add_f32 v49, v49, v53
  v_mfma_f32_16x16x32_bf16 v[40:43], v[184:187], a[24:27], v[40:43]
  buffer_load_dwordx4 a[80:83], v14, s[28:31], s58 offen offset:1024 sc1
  v_mfma_f32_16x16x32_bf16 v[44:47], v[188:191], a[24:27], v[44:47]
  v_add_f32 v50, v50, v54
  v_add_f32 v51, v51, v55
  v_mfma_f32_16x16x32_bf16 v[32:35], v[192:195], a[28:31], v[32:35]
  s_waitcnt lgkmcnt(0)
  v_add_f32 v56, v56, v60
  v_add_f32 v57, v57, v61
  v_mfma_f32_16x16x32_bf16 v[36:39], v[196:199], a[28:31], v[36:39]
  buffer_load_dwordx4 a[84:87], v14, s[28:31], s68 offen offset:2048 sc1
  v_mfma_f32_16x16x32_bf16 v[40:43], v[200:203], a[28:31], v[40:43]
  v_add_f32 v58, v58, v62
  v_add_f32 v59, v59, v63
  v_mfma_f32_16x16x32_bf16 v[44:47], v[204:207], a[28:31], v[44:47]
  v_add_f32 v48, v48, v64
  v_add_f32 v49, v49, v65
  v_mfma_f32_16x16x32_bf16 v[32:35], v[208:211], a[32:35], v[32:35]
  v_add_f32 v50, v50, v66
  v_add_f32 v51, v51, v67
  v_mfma_f32_16x16x32_bf16 v[36:39], v[212:215], a[32:35], v[36:39]
  v_add_f32 v48, v48, v56
  v_add_f32 v49, v49, v57
  v_mfma_f32_16x16x32_bf16 v[40:43], v[216:219], a[32:35], v[40:43]
  v_add_f32 v50, v50, v58
  v_add_f32 v51, v51, v59
  v_mfma_f32_16x16x32_bf16 v[44:47], v[220:223], a[32:35], v[44:47]
  s_waitcnt vmcnt(3)
  v_cmp_ne_u32 vcc, s71, v6
  s_nop 1
  s_cbranch_vccnz pf43_retry
pf43_ok:
  v_mfma_f32_16x16x32_bf16 v[32:35], v[224:227], a[36:39], v[32:35]
  buffer_load_dwordx4 a[88:91], v12, s[28:31], s59 offen offset:0 sc1
  v_mfma_f32_16x16x32_bf16 v[36:39], v[228:231], a[36:39], v[36:39]
  v_cvt_pk_bf16_f32 v80, v48, v49
  v_cvt_pk_bf16_f32 v81, v50, v51
  v_mfma_f32_16x16x32_bf16 v[40:43], v[232:235], a[36:39], v[40:43]
  v_mfma_f32_16x16x32_bf16 v[44:47], v[236:239], a[36:39], v[44:47]
  buffer_load_dwordx4 a[92:95], v12, s[28:31], s59 offen offset:1024 sc1
  v_mfma_f32_16x16x32_bf16 v[32:35], v[240:243], a[40:43], v[32:35]
  v_mfma_f32_16x16x32_bf16 v[36:39], v[244:247], a[40:43], v[36:39]
  v_mfma_f32_16x16x32_bf16 v[40:43], v[248:251], a[40:43], v[40:43]
  buffer_load_dwordx4 a[96:99], v12, s[28:31], s59 offen offset:2048 sc1
  v_mfma_f32_16x16x32_bf16 v[44:47], v[252:255], a[40:43], v[44:47]
  v_mfma_f32_16x16x32_bf16 v[16:19], a[192:195], a[44:47], 0
  v_mfma_f32_16x16x32_bf16 v[20:23], a[196:199], a[44:47], 0
  buffer_load_dwordx4 a[100:103], v12, s[28:31], s59 offen offset:3072 sc1
  v_mfma_f32_16x16x32_bf16 v[24:27], a[200:203], a[44:47], 0
  ds_write_b128 v78, v[32:35] offset:0
  v_mfma_f32_16x16x32_bf16 v[28:31], a[204:207], a[44:47], 0
  ds_write_b128 v78, v[36:39] offset:1312
  v_mfma_f32_16x16x32_bf16 v[16:19], a[208:211], a[48:51], v[16:19]
  buffer_load_dwordx4 a[104:107], v13, s[28:31], s59 offen offset:0 sc1
  v_mfma_f32_16x16x32_bf16 v[20:23], a[212:215], a[48:51], v[20:23]
  ds_write_b128 v78, v[40:43] offset:2624
  v_mfma_f32_16x16x32_bf16 v[24:27], a[216:219], a[48:51], v[24:27]
  ds_write_b128 v78, v[44:47] offset:3936
  v_mfma_f32_16x16x32_bf16 v[28:31], a[220:223], a[48:51], v[28:31]
  buffer_load_dwordx4 a[108:111], v13, s[28:31], s59 offen offset:1024 sc1
  v_mfma_f32_16x16x32_bf16 v[16:19], a[224:227], a[52:55], v[16:19]
  ds_read_b32 v66, v15 offset:16384
  ds_read_b32 v67, v15 offset:18432
  v_mfma_f32_16x16x32_bf16 v[20:23], a[228:231], a[52:55], v[20:23]
  v_mfma_f32_16x16x32_bf16 v[24:27], a[232:235], a[52:55], v[24:27]
  buffer_load_dwordx4 a[112:115], v13, s[28:31], s59 offen offset:2048 sc1
  v_mfma_f32_16x16x32_bf16 v[28:31], a[236:239], a[52:55], v[28:31]
  v_mfma_f32_16x16x32_bf16 v[16:19], a[240:243], a[56:59], v[16:19]
  v_mfma_f32_16x16x32_bf16 v[20:23], a[244:247], a[56:59], v[20:23]
  buffer_load_dwordx4 a[116:119], v13, s[28:31], s59 offen offset:3072 sc1
  v_mfma_f32_16x16x32_bf16 v[24:27], a[248:251], a[56:59], v[24:27]
  s_waitcnt lgkmcnt(0)
  s_barrier
  ds_read_b128 v[48:51], v79 offset:0
  v_mfma_f32_16x16x32_bf16 v[28:31], a[252:255], a[56:59], v[28:31]
  ds_read_b128 v[52:55], v79 offset:5248
  ds_read_b128 v[56:59], v79 offset:10496
  v_mfma_f32_16x16x32_bf16 v[16:19], v[144:147], a[60:63], v[16:19]
  buffer_load_dwordx4 a[120:123], v14, s[28:31], s59 offen offset:0 sc1
  v_mfma_f32_16x16x32_bf16 v[20:23], v[148:151], a[60:63], v[20:23]
  ds_read_b128 v[60:63], v79 offset:15744
  v_lshlrev_b32 v64, 16, v66
  v_mfma_f32_16x16x32_bf16 v[24:27], v[152:155], a[60:63], v[24:27]
  v_and_b32 v65, 0xffff0000, v66
  v_lshlrev_b32 v66, 16, v67
  v_mfma_f32_16x16x32_bf16 v[28:31], v[156:159], a[60:63], v[28:31]
  buffer_load_dwordx4 a[124:127], v14, s[28:31], s59 offen offset:1024 sc1
  v_mfma_f32_16x16x32_bf16 v[16:19], v[160:163], a[64:67], v[16:19]
  v_and_b32 v67, 0xffff0000, v67
  v_fma_f32 v64, v64, v139, v138
  v_mfma_f32_16x16x32_bf16 v[20:23], v[164:167], a[64:67], v[20:23]
  v_fma_f32 v65, v65, v139, v138
  v_fma_f32 v66, v66, v139, v138
  v_mfma_f32_16x16x32_bf16 v[24:27], v[168:171], a[64:67], v[24:27]
  buffer_load_dwordx4 a[128:131], v14, s[28:31], s69 offen offset:2048 sc1
  v_mfma_f32_16x16x32_bf16 v[28:31], v[172:175], a[64:67], v[28:31]
  v_fma_f32 v67, v67, v139, v138
  v_add_f32 v64, v64, v132
  v_mfma_f32_16x16x32_bf16 v[16:19], v[176:179], a[68:71], v[16:19]
  v_add_f32 v65, v65, v133
  v_add_f32 v66, v66, v134
  v_mfma_f32_16x16x32_bf16 v[20:23], v[180:183], a[68:71], v[20:23]
  v_add_f32 v67, v67, v135
  s_waitcnt lgkmcnt(2)
  v_add_f32 v48, v48, v52
  v_mfma_f32_16x16x32_bf16 v[24:27], v[184:187], a[68:71], v[24:27]
  v_add_f32 v49, v49, v53
  v_add_f32 v50, v50, v54
  v_mfma_f32_16x16x32_bf16 v[28:31], v[188:191], a[68:71], v[28:31]
  v_add_f32 v51, v51, v55
  s_waitcnt lgkmcnt(0)
  v_add_f32 v56, v56, v60
  v_mfma_f32_16x16x32_bf16 v[16:19], v[192:195], a[72:75], v[16:19]
  v_add_f32 v57, v57, v61
  v_add_f32 v58, v58, v62
  v_mfma_f32_16x16x32_bf16 v[20:23], v[196:199], a[72:75], v[20:23]
  v_add_f32 v59, v59, v63
  v_add_f32 v48, v48, v64
  v_mfma_f32_16x16x32_bf16 v[24:27], v[200:203], a[72:75], v[24:27]
  v_add_f32 v49, v49, v65
  v_add_f32 v50, v50, v66
  v_mfma_f32_16x16x32_bf16 v[28:31], v[204:207], a[72:75], v[28:31]
  buffer_store_dwordx2 v[80:81], v2, s[52:55], s19 offen sc1
  s_waitcnt vmcnt(14)
  v_mfma_f32_16x16x32_bf16 v[16:19], v[208:211], a[76:79], v[16:19]
  s_add_u32 s19, s19, 32768
  v_add_f32 v51, v51, v67
  v_mfma_f32_16x16x32_bf16 v[20:23], v[212:215], a[76:79], v[20:23]
  v_add_f32 v48, v48, v56
  v_add_f32 v49, v49, v57
  v_mfma_f32_16x16x32_bf16 v[24:27], v[216:219], a[76:79], v[24:27]
  v_add_f32 v50, v50, v58
  v_add_f32 v51, v51, v59
  v_mfma_f32_16x16x32_bf16 v[28:31], v[220:223], a[76:79], v[28:31]
  v_cvt_pk_bf16_f32 v82, v48, v49
  v_cvt_pk_bf16_f32 v83, v50, v51
  s_waitcnt vmcnt(13)
  v_mfma_f32_16x16x32_bf16 v[16:19], v[224:227], a[80:83], v[16:19]
  buffer_store_dwordx2 v[82:83], v2, s[52:55], s19 offen sc1
  v_mfma_f32_16x16x32_bf16 v[20:23], v[228:231], a[80:83], v[20:23]
  s_add_u32 s19, s19, 32768
  v_mfma_f32_16x16x32_bf16 v[24:27], v[232:235], a[80:83], v[24:27]
  v_mfma_f32_16x16x32_bf16 v[28:31], v[236:239], a[80:83], v[28:31]
  s_waitcnt vmcnt(13)
  v_mfma_f32_16x16x32_bf16 v[16:19], v[240:243], a[84:87], v[16:19]
  v_mfma_f32_16x16x32_bf16 v[20:23], v[244:247], a[84:87], v[20:23]
  v_mfma_f32_16x16x32_bf16 v[24:27], v[248:251], a[84:87], v[24:27]
  v_mfma_f32_16x16x32_bf16 v[28:31], v[252:255], a[84:87], v[28:31]
  s_waitcnt vmcnt(12)
  v_mfma_f32_16x16x32_bf16 v[32:35], a[192:195], a[88:91], 0
  v_mfma_f32_16x16x32_bf16 v[36:39], a[196:199], a[88:91], 0
  s_nop 1
  ds_write_b128 v10, v[16:19] offset:0
  v_mfma_f32_16x16x32_bf16 v[40:43], a[200:203], a[88:91], 0
  ds_write_b128 v10, v[20:23] offset:1312
  v_mfma_f32_16x16x32_bf16 v[44:47], a[204:207], a[88:91], 0
  ds_write_b128 v10, v[24:27] offset:2624
  s_waitcnt vmcnt(11)
  v_mfma_f32_16x16x32_bf16 v[32:35], a[208:211], a[92:95], v[32:35]
  ds_write_b128 v10, v[28:31] offset:3936
  v_mfma_f32_16x16x32_bf16 v[36:39], a[212:215], a[92:95], v[36:39]
  ds_read_b32 v66, v86 offset:0
  ds_read_b32 v67, v86 offset:2048
  v_mfma_f32_16x16x32_bf16 v[40:43], a[216:219], a[92:95], v[40:43]
  v_mfma_f32_16x16x32_bf16 v[44:47], a[220:223], a[92:95], v[44:47]
  s_waitcnt vmcnt(10)
  v_mfma_f32_16x16x32_bf16 v[32:35], a[224:227], a[96:99], v[32:35]
  v_mfma_f32_16x16x32_bf16 v[36:39], a[228:231], a[96:99], v[36:39]
  v_mfma_f32_16x16x32_bf16 v[40:43], a[232:235], a[96:99], v[40:43]
  s_waitcnt lgkmcnt(0)
  s_barrier
  ds_read_b128 v[48:51], v11 offset:0
  v_mfma_f32_16x16x32_bf16 v[44:47], a[236:239], a[96:99], v[44:47]
  ds_read_b128 v[52:55], v11 offset:5248
  ds_read_b128 v[56:59], v11 offset:10496
  s_waitcnt vmcnt(9)
  v_mfma_f32_16x16x32_bf16 v[32:35], a[240:243], a[100:103], v[32:35]
  ds_read_b128 v[60:63], v11 offset:15744
  v_lshlrev_b32 v64, 16, v66
  v_mfma_f32_16x16x32_bf16 v[36:39], a[244:247], a[100:103], v[36:39]
  v_and_b32 v65, 0xffff0000, v66
  v_lshlrev_b32 v66, 16, v67
  v_mfma_f32_16x16x32_bf16 v[40:43], a[248:251], a[100:103], v[40:43]
  v_and_b32 v67, 0xffff0000, v67
  v_fma_f32 v64, v64, v141, v140
  v_mfma_f32_16x16x32_bf16 v[44:47], a[252:255], a[100:103], v[44:47]
  v_fma_f32 v65, v65, v141, v140
  v_fma_f32 v66, v66, v141, v140
  s_waitcnt vmcnt(8)
  v_mfma_f32_16x16x32_bf16 v[32:35], v[144:147], a[104:107], v[32:35]
  v_fma_f32 v67, v67, v141, v140
  v_add_f32 v64, v64, v132
  v_mfma_f32_16x16x32_bf16 v[36:39], v[148:151], a[104:107], v[36:39]
  v_add_f32 v65, v65, v133
  v_add_f32 v66, v66, v134
  v_mfma_f32_16x16x32_bf16 v[40:43], v[152:155], a[104:107], v[40:43]
  v_add_f32 v67, v67, v135
  s_waitcnt lgkmcnt(2)
  v_add_f32 v48, v48, v52
  v_mfma_f32_16x16x32_bf16 v[44:47], v[156:159], a[104:107], v[44:47]
  v_add_f32 v49, v49, v53
  v_add_f32 v50, v50, v54
  s_waitcnt vmcnt(7)
  v_mfma_f32_16x16x32_bf16 v[32:35], v[160:163], a[108:111], v[32:35]
  v_add_f32 v51, v51, v55
  s_waitcnt lgkmcnt(0)
  v_add_f32 v56, v56, v60
  v_mfma_f32_16x16x32_bf16 v[36:39], v[164:167], a[108:111], v[36:39]
  v_add_f32 v57, v57, v61
  v_add_f32 v58, v58, v62
  v_mfma_f32_16x16x32_bf16 v[40:43], v[168:171], a[108:111], v[40:43]
  v_add_f32 v59, v59, v63
  v_add_f32 v48, v48, v64
  v_mfma_f32_16x16x32_bf16 v[44:47], v[172:175], a[108:111], v[44:47]
  v_add_f32 v49, v49, v65
  v_add_f32 v50, v50, v66
  s_waitcnt vmcnt(6)
  v_mfma_f32_16x16x32_bf16 v[32:35], v[176:179], a[112:115], v[32:35]
  v_add_f32 v51, v51, v67
  v_add_f32 v48, v48, v56
  v_mfma_f32_16x16x32_bf16 v[36:39], v[180:183], a[112:115], v[36:39]
  v_add_f32 v49, v49, v57
  v_add_f32 v50, v50, v58
  v_mfma_f32_16x16x32_bf16 v[40:43], v[184:187], a[112:115], v[40:43]
  v_add_f32 v51, v51, v59
  v_cvt_pk_bf16_f32 v84, v48, v49
  v_mfma_f32_16x16x32_bf16 v[44:47], v[188:191], a[112:115], v[44:47]
  v_cvt_pk_bf16_f32 v85, v50, v51
  buffer_store_dwordx2 v[84:85], v2, s[52:55], s19 offen sc1
  s_waitcnt vmcnt(6)
  v_mfma_f32_16x16x32_bf16 v[32:35], v[192:195], a[116:119], v[32:35]
  s_add_u32 s19, s19, 32768
  v_mfma_f32_16x16x32_bf16 v[36:39], v[196:199], a[116:119], v[36:39]
  v_mfma_f32_16x16x32_bf16 v[40:43], v[200:203], a[116:119], v[40:43]
  v_mfma_f32_16x16x32_bf16 v[44:47], v[204:207], a[116:119], v[44:47]
  s_waitcnt vmcnt(5)
  v_mfma_f32_16x16x32_bf16 v[32:35], v[208:211], a[120:123], v[32:35]
  v_mfma_f32_16x16x32_bf16 v[36:39], v[212:215], a[120:123], v[36:39]
  v_mfma_f32_16x16x32_bf16 v[40:43], v[216:219], a[120:123], v[40:43]
  v_mfma_f32_16x16x32_bf16 v[44:47], v[220:223], a[120:123], v[44:47]
  s_waitcnt vmcnt(4)
  v_mfma_f32_16x16x32_bf16 v[32:35], v[224:227], a[124:127], v[32:35]
  v_mfma_f32_16x16x32_bf16 v[36:39], v[228:231], a[124:127], v[36:39]
  v_mfma_f32_16x16x32_bf16 v[40:43], v[232:235], a[124:127], v[40:43]
  v_mfma_f32_16x16x32_bf16 v[44:47], v[236:239], a[124:127], v[44:47]
  s_waitcnt vmcnt(3)
  v_mfma_f32_16x16x32_bf16 v[32:35], v[240:243], a[128:131], v[32:35]
  v_mfma_f32_16x16x32_bf16 v[36:39], v[244:247], a[128:131], v[36:39]
  v_mfma_f32_16x16x32_bf16 v[40:43], v[248:251], a[128:131], v[40:43]
  v_mfma_f32_16x16x32_bf16 v[44:47], v[252:255], a[128:131], v[44:47]
  s_nop 4
  ds_write_b128 v78, v[32:35] offset:0
  ds_write_b128 v78, v[36:39] offset:1312
  ds_write_b128 v78, v[40:43] offset:2624
  ds_write_b128 v78, v[44:47] offset:3936
  ds_read_b32 v66, v86 offset:16384
  ds_read_b32 v67, v86 offset:18432
  s_waitcnt lgkmcnt(0)
  s_barrier
  ds_read_b128 v[48:51], v79 offset:0
  ds_read_b128 v[52:55], v79 offset:5248
  ds_read_b128 v[56:59], v79 offset:10496
  ds_read_b128 v[60:63], v79 offset:15744
  v_lshlrev_b32 v64, 16, v66
  v_and_b32 v65, 0xffff0000, v66
  v_lshlrev_b32 v66, 16, v67
  v_and_b32 v67, 0xffff0000, v67
  v_fma_f32 v64, v64, v143, v142
  v_fma_f32 v65, v65, v143, v142
  v_fma_f32 v66, v66, v143, v142
  v_fma_f32 v67, v67, v143, v142
  v_add_f32 v64, v64, v132
  v_add_f32 v65, v65, v133
  v_add_f32 v66, v66, v134
  v_add_f32 v67, v67, v135
  s_waitcnt lgkmcnt(2)
  v_add_f32 v48, v48, v52
  v_add_f32 v49, v49, v53
  v_add_f32 v50, v50, v54
  v_add_f32 v51, v51, v55
  s_waitcnt lgkmcnt(0)
  v_add_f32 v56, v56, v60
  v_add_f32 v57, v57, v61
  v_add_f32 v58, v58, v62
  v_add_f32 v59, v59, v63
  v_add_f32 v48, v48, v64
  v_add_f32 v49, v49, v65
  v_add_f32 v50, v50, v66
  v_add_f32 v51, v51, v67
  v_add_f32 v48, v48, v56
  v_add_f32 v49, v49, v57
  v_add_f32 v50, v50, v58
  v_add_f32 v51, v51, v59
  v_cvt_pk_bf16_f32 v80, v48, v49
  v_cvt_pk_bf16_f32 v81, v50, v51
  buffer_store_dwordx2 v[80:81], v2, s[52:55], s19 offen sc1
  s_or_b32 s12, s22, s3
  s_cmp_eq_u32 s12, 0
  s_cselect_b32 s12, 0, 2146435072
  v_mov_b32 v4, s72
  buffer_store_dword v4, v3, s[28:31], s12 offen
L_end:
  s_endpgm
pz_retry:
  s_mov_b32 s10, 0
  s_mov_b32 s0, 0
pz_loop:
  s_add_u32 s10, s10, 1
  s_cmp_gt_u32 s10, 6000
  s_cbranch_scc1 pz_out
  buffer_load_dwordx4 v[16:19], v171, s[28:31], s56 offen sc1
  buffer_load_dwordx4 v[20:23], v171, s[28:31], s57 offen sc1
  s_waitcnt vmcnt(0)
  v_bitop3_b32 v176, v16, v17, s21 bitop3:0x7e
  v_bitop3_b32 v177, v18, v19, s21 bitop3:0x7e
  v_bitop3_b32 v178, v20, v21, s21 bitop3:0x7e
  v_bitop3_b32 v179, v22, v23, s21 bitop3:0x7e
  v_or3_b32 v176, v176, v177, v178
  v_or_b32 v176, v176, v179
  v_and_b32 v176, 0x00070007, v176
  v_cmp_ne_u32 vcc, 0, v176
  s_nop 1
  s_cbranch_vccnz pz_loop
pz_out:
  s_waitcnt vmcnt(0)
  s_nop 7
  s_branch pz_ok
pwf_retry:
  s_mov_b32 s10, 0
  s_mov_b32 s0, 0
pwf_loop:
  s_add_u32 s10, s10, 1
  s_cmp_gt_u32 s10, 6000
  s_cbranch_scc1 pwf_out
  buffer_load_dwordx2 v[32:33], v173, s[28:31], s63 offen offset:2048 sc1
  buffer_load_dwordx2 v[36:37], v173, s[28:31], s63 offen offset:3072 sc1
  v_mov_b32 v39, s71
  s_waitcnt vmcnt(0)
  v_cmpx_eq_u32 vcc, s71, v32
  v_cmpx_eq_u32 vcc, s71, v33
  s_nop 0
  s_cmp_eq_u64 exec, -1
  s_mov_b64 exec, -1
  s_cbranch_scc1 pwf_out
  v_cmp_eq_u32 vcc, s72, v36
  s_nop 1
  v_cndmask_b32 v32, v32, v39, vcc
  v_cmp_eq_u32 vcc, s72, v37
  s_nop 1
  v_cndmask_b32 v33, v33, v39, vcc
  v_cmpx_eq_u32 vcc, s71, v32
  v_cmpx_eq_u32 vcc, s71, v33
  s_nop 0
  s_cmp_eq_u64 exec, -1
  s_mov_b64 exec, -1
  s_mov_b32 s1, 0
  s_cbranch_scc0 pwf_c
  s_mov_b32 s1, 1
  s_mov_b32 s70, 1
pwf_c:
  s_cmp_ge_u32 s10, 40
  s_cselect_b32 s70, 1, s70
  s_andn2_b32 s20, s70, s0
  s_cbranch_scc0 pwf_norel
  s_mov_b32 s0, 1
  buffer_wbl2 sc1
  s_waitcnt vmcnt(0)
  v_cmp_eq_u32 vcc, 0, v0
  v_mov_b32 v39, 0
  v_mov_b32 v38, s72
  s_mov_b64 exec, vcc
  s_lshl_b32 s11, s26, 4
  s_add_u32 s11, s11, s63
  s_lshl_b32 s20, s3, 2
  s_add_u32 s11, s11, s20
  buffer_store_dword v38, v39, s[28:31], s11 offen offset:3072 sc1
  s_mov_b64 exec, -1
pwf_norel:
  s_cmp_eq_u32 s1, 0
  s_cbranch_scc1 pwf_loop
pwf_out:
  s_waitcnt vmcnt(0)
  s_nop 7
  s_branch pwf_ok
pz2_retry:
  s_mov_b32 s10, 0
  s_mov_b32 s0, 0
pz2_loop:
  s_add_u32 s10, s10, 1
  s_cmp_gt_u32 s10, 6000
  s_cbranch_scc1 pz2_out
  buffer_load_dword v216, v28, s[28:31], s56 offen offset:0 sc1
  buffer_load_dword v217, v28, s[28:31], s56 offen offset:256 sc1
  buffer_load_dword v218, v28, s[28:31], s56 offen offset:512 sc1
  buffer_load_dword v219, v28, s[28:31], s56 offen offset:768 sc1
  buffer_load_dword v220, v28, s[28:31], s57 offen offset:0 sc1
  buffer_load_dword v221, v28, s[28:31], s57 offen offset:256 sc1
  buffer_load_dword v222, v28, s[28:31], s57 offen offset:512 sc1
  buffer_load_dword v223, v28, s[28:31], s57 offen offset:768 sc1
  s_waitcnt vmcnt(0)
  v_max3_u32 v240, v216, v217, v218
  v_max3_u32 v241, v219, v220, v221
  v_max3_u32 v240, v240, v222, v223
  v_max_u32 v240, v240, v241
  v_cmp_eq_u32 vcc, -1, v240
  s_nop 1
  s_cbranch_vccnz pz2_loop
pz2_out:
  s_waitcnt vmcnt(0)
  s_nop 7
  s_branch pz2_ok
pf3_retry:
  s_mov_b32 s10, 0
  s_mov_b32 s0, 0
pf3_loop:
  s_add_u32 s10, s10, 1
  s_cmp_gt_u32 s10, 6000
  s_cbranch_scc1 pf3_out
  buffer_load_dword v6, v5, s[28:31], s65 offen offset:128 sc1
  buffer_load_dword v8, v5, s[28:31], s65 offen offset:1152 sc1
  v_mov_b32 v9, s71
  s_waitcnt vmcnt(0)
  v_cmp_ne_u32 vcc, s71, v6
  s_nop 1
  s_cbranch_vccz pf3_out
  v_cmp_eq_u32 vcc, s72, v8
  s_nop 1
  v_cndmask_b32 v6, v6, v9, vcc
  v_cmp_ne_u32 vcc, s71, v6
  s_mov_b32 s1, 0
  s_nop 0
  s_cbranch_vccnz pf3_c
  s_mov_b32 s1, 1
  s_mov_b32 s70, 1
pf3_c:
  s_cmp_ge_u32 s10, 40
  s_cselect_b32 s70, 1, s70
  s_andn2_b32 s20, s70, s0
  s_cbranch_scc0 pf3_norel
  s_mov_b32 s0, 1
  buffer_wbl2 sc1
  s_waitcnt vmcnt(0)
  v_cmp_eq_u32 vcc, 0, v0
  v_mov_b32 v9, 0
  v_mov_b32 v8, s72
  s_mov_b64 exec, vcc
  s_mov_b32 s11, s12
  buffer_store_dword v8, v9, s[28:31], s11 offen offset:1152 sc1
  s_mov_b64 exec, -1
pf3_norel:
  s_cmp_eq_u32 s1, 0
  s_cbranch_scc1 pf3_loop
pf3_out:
  s_waitcnt vmcnt(0)
  s_nop 7
  s_branch pf3_ok
pf40_retry:
  s_mov_b32 s10, 0
  s_mov_b32 s0, 0
pf40_loop:
  s_add_u32 s10, s10, 1
  s_cmp_gt_u32 s10, 6000
  s_cbranch_scc1 pf40_out
  buffer_load_dword v6, v5, s[28:31], s65 offen offset:256 sc1
  buffer_load_dword v8, v5, s[28:31], s65 offen offset:1280 sc1
  v_mov_b32 v9, s71
  s_waitcnt vmcnt(0)
  v_cmp_ne_u32 vcc, s71, v6
  s_nop 1
  s_cbranch_vccz pf40_out
  v_cmp_eq_u32 vcc, s72, v8
  s_nop 1
  v_cndmask_b32 v6, v6, v9, vcc
  v_cmp_ne_u32 vcc, s71, v6
  s_mov_b32 s1, 0
  s_nop 0
  s_cbranch_vccnz pf40_c
  s_mov_b32 s1, 1
  s_mov_b32 s70, 1
pf40_c:
  s_cmp_ge_u32 s10, 40
  s_cselect_b32 s70, 1, s70
  s_andn2_b32 s20, s70, s0
  s_cbranch_scc0 pf40_norel
  s_mov_b32 s0, 1
  buffer_wbl2 sc1
  s_waitcnt vmcnt(0)
  v_cmp_eq_u32 vcc, 0, v0
  v_mov_b32 v9, 0
  v_mov_b32 v8, s72
  s_mov_b64 exec, vcc
  s_mov_b32 s11, s12
  buffer_store_dword v8, v9, s[28:31], s11 offen offset:1280 sc1
  s_mov_b64 exec, -1
pf40_norel:
  s_cmp_eq_u32 s1, 0
  s_cbranch_scc1 pf40_loop
pf40_out:
  s_waitcnt vmcnt(0)
  s_nop 7
  s_branch pf40_ok
pf41_retry:
  s_mov_b32 s10, 0
  s_mov_b32 s0, 0
pf41_loop:
  s_add_u32 s10, s10, 1
  s_cmp_gt_u32 s10, 6000
  s_cbranch_scc1 pf41_out
  buffer_load_dword v6, v5, s[28:31], s65 offen offset:384 sc1
  buffer_load_dword v8, v5, s[28:31], s65 offen offset:1408 sc1
  v_mov_b32 v9, s71
  s_waitcnt vmcnt(0)
  v_cmp_ne_u32 vcc, s71, v6
  s_nop 1
  s_cbranch_vccz pf41_out
  v_cmp_eq_u32 vcc, s72, v8
  s_nop 1
  v_cndmask_b32 v6, v6, v9, vcc
  v_cmp_ne_u32 vcc, s71, v6
  s_mov_b32 s1, 0
  s_nop 0
  s_cbranch_vccnz pf41_c
  s_mov_b32 s1, 1
  s_mov_b32 s70, 1
pf41_c:
  s_cmp_ge_u32 s10, 40
  s_cselect_b32 s70, 1, s70
  s_andn2_b32 s20, s70, s0
  s_cbranch_scc0 pf41_norel
  s_mov_b32 s0, 1
  buffer_wbl2 sc1
  s_waitcnt vmcnt(0)
  v_cmp_eq_u32 vcc, 0, v0
  v_mov_b32 v9, 0
  v_mov_b32 v8, s72
  s_mov_b64 exec, vcc
  s_mov_b32 s11, s12
  buffer_store_dword v8, v9, s[28:31], s11 offen offset:1408 sc1
  s_mov_b64 exec, -1
pf41_norel:
  s_cmp_eq_u32 s1, 0
  s_cbranch_scc1 pf41_loop
pf41_out:
  s_waitcnt vmcnt(0)
  s_nop 7
  s_branch pf41_ok
pf42_retry:
  s_mov_b32 s10, 0
  s_mov_b32 s0, 0
pf42_loop:
  s_add_u32 s10, s10, 1
  s_cmp_gt_u32 s10, 6000
  s_cbranch_scc1 pf42_out
  buffer_load_dword v6, v5, s[28:31], s65 offen offset:512 sc1
  buffer_load_dword v8, v5, s[28:31], s65 offen offset:1536 sc1
  v_mov_b32 v9, s71
  s_waitcnt vmcnt(0)
  v_cmp_ne_u32 vcc, s71, v6
  s_nop 1
  s_cbranch_vccz pf42_out
  v_cmp_eq_u32 vcc, s72, v8
  s_nop 1
  v_cndmask_b32 v6, v6, v9, vcc
  v_cmp_ne_u32 vcc, s71, v6
  s_mov_b32 s1, 0
  s_nop 0
  s_cbranch_vccnz pf42_c
  s_mov_b32 s1, 1
  s_mov_b32 s70, 1
pf42_c:
  s_cmp_ge_u32 s10, 40
  s_cselect_b32 s70, 1, s70
  s_andn2_b32 s20, s70, s0
  s_cbranch_scc0 pf42_norel
  s_mov_b32 s0, 1
  buffer_wbl2 sc1
  s_waitcnt vmcnt(0)
  v_cmp_eq_u32 vcc, 0, v0
  v_mov_b32 v9, 0
  v_mov_b32 v8, s72
  s_mov_b64 exec, vcc
  s_mov_b32 s11, s12
  buffer_store_dword v8, v9, s[28:31], s11 offen offset:1536 sc1
  s_mov_b64 exec, -1
pf42_norel:
  s_cmp_eq_u32 s1, 0
  s_cbranch_scc1 pf42_loop
pf42_out:
  s_waitcnt vmcnt(0)
  s_nop 7
  s_branch pf42_ok
pf43_retry:
  s_mov_b32 s10, 0
  s_mov_b32 s0, 0
pf43_loop:
  s_add_u32 s10, s10, 1
  s_cmp_gt_u32 s10, 6000
  s_cbranch_scc1 pf43_out
  buffer_load_dword v6, v5, s[28:31], s65 offen offset:640 sc1
  buffer_load_dword v8, v5, s[28:31], s65 offen offset:1664 sc1
  v_mov_b32 v9, s71
  s_waitcnt vmcnt(0)
  v_cmp_ne_u32 vcc, s71, v6
  s_nop 1
  s_cbranch_vccz pf43_out
  v_cmp_eq_u32 vcc, s72, v8
  s_nop 1
  v_cndmask_b32 v6, v6, v9, vcc
  v_cmp_ne_u32 vcc, s71, v6
  s_mov_b32 s1, 0
  s_nop 0
  s_cbranch_vccnz pf43_c
  s_mov_b32 s1, 1
  s_mov_b32 s70, 1
pf43_c:
  s_cmp_ge_u32 s10, 40
  s_cselect_b32 s70, 1, s70
  s_andn2_b32 s20, s70, s0
  s_cbranch_scc0 pf43_norel
  s_mov_b32 s0, 1
  buffer_wbl2 sc1
  s_waitcnt vmcnt(0)
  v_cmp_eq_u32 vcc, 0, v0
  v_mov_b32 v9, 0
  v_mov_b32 v8, s72
  s_mov_b64 exec, vcc
  s_mov_b32 s11, s12
  buffer_store_dword v8, v9, s[28:31], s11 offen offset:1664 sc1
  s_mov_b64 exec, -1
pf43_norel:
  s_cmp_eq_u32 s1, 0
  s_cbranch_scc1 pf43_loop
pf43_out:
  s_waitcnt vmcnt(0)
  s_nop 7
  s_branch pf43_ok
.fill 4096, 4, 0xbf800000
.section .rodata,"a"
.p2align 6
.amdhsa_kernel sequential_preLN__spectral_gfnet__dense_activation_squared_relu__prompt_kernel
  .amdhsa_next_free_vgpr 512
  .amdhsa_next_free_sgpr 102
  .amdhsa_accum_offset 256
  .amdhsa_group_segment_fixed_size 0
  .amdhsa_kernarg_size 88
  .amdhsa_user_sgpr_count 2
  .amdhsa_user_sgpr_kernarg_segment_ptr 1
  .amdhsa_system_sgpr_workgroup_id_x 1
.end_amdhsa_kernel
```
